```python
import torch

def _softmax(x, axis=-1):
    return torch.softmax(x, dim=axis)
def _gelu(x):
    return torch.nn.functional.gelu(x, approximate="tanh")
def _silu(x):
    return torch.nn.functional.silu(x)
def _sigmoid(x):
    return torch.sigmoid(x)
def _layernorm(x, axis=-1, eps=1e-5):
    m = x.mean(dim=axis, keepdim=True)
    v = x.var(dim=axis, keepdim=True, unbiased=False)
    return (x - m) / torch.sqrt(v + eps)
def _scatter_add(tgt, idx, src, axis=0):
    return tgt.clone().index_add_(axis, idx, src)
def _segment_sum(src, seg, n):
    out = torch.zeros((n,) + src.shape[1:], dtype=src.dtype)
    return out.index_add_(0, seg, src)
def _pad(x, pw):
    flat = tuple(v for pair in reversed(pw) for v in pair)
    return torch.nn.functional.pad(x, flat)

kernel_name = 'sequential_preLN__mha_block__moe_arch_mod__prompt'

def setup_inputs():

    _w = (lambda a: (lambda t: t.to(torch.bfloat16) if t.is_floating_point() else t)(torch.as_tensor(a)))
    def _A_setup():
        B, S, D, H = 1, 2048, 512, 32
        return {
            "x": _w((lambda *s: torch.randn(*s, dtype=torch.bfloat16) * 0.05)(B, S, D)),
            "wqkv": _w((lambda *s: torch.randn(*s, dtype=torch.bfloat16) * 0.05)(D, 3 * D)),
            "wo": _w((lambda *s: torch.randn(*s, dtype=torch.bfloat16) * 0.05)(D, D)),
        }
    _A_in = _A_setup()

    def _B_setup():
        B, S, D, F, C = 1, 2048, 512, 1792, 1
        return {
            "x": _w((lambda *s: torch.randn(*s, dtype=torch.bfloat16) * 0.05)(B, S, D)),
            "w_r": _w((lambda *s: torch.randn(*s, dtype=torch.bfloat16) * 0.05)(D)),
            "w_gate": _w((lambda *s: torch.randn(*s, dtype=torch.bfloat16) * 0.05)(D, F)),
            "w_up": _w((lambda *s: torch.randn(*s, dtype=torch.bfloat16) * 0.05)(D, F)),
            "w_down": _w((lambda *s: torch.randn(*s, dtype=torch.bfloat16) * 0.05)(F, D)),
        }
    _B_in = _B_setup()

    return {
        "A_x": _A_in["x"],
        "A_wqkv": _A_in["wqkv"],
        "A_wo": _A_in["wo"],
        "B_x": _B_in["x"],
        "B_w_r": _B_in["w_r"],
        "B_w_gate": _B_in["w_gate"],
        "B_w_up": _B_in["w_up"],
        "B_w_down": _B_in["w_down"],
    }

def reference(A_x, A_wqkv, A_wo, B_x, B_w_r, B_w_gate, B_w_up, B_w_down):
    def _A_ref(x, wqkv, wo):
        B, S, D = x.shape
        H = 32
        Dh = D // H
        qkv = (lambda x, *d: x.permute(*d))((x @ wqkv).reshape(B, S, 3, H, Dh), 2, 0, 3, 1, 4)
        q, k, v = qkv[0], qkv[1], qkv[2]
        scores = torch.einsum("bhqd,bhkd->bhqk", q, k) * (Dh ** -0.5)
        p = _softmax(scores, axis=-1)
        o = torch.einsum("bhqk,bhkd->bhqd", p, v)
        return (lambda x, *d: x.permute(*d))(o, 0, 2, 1, 3).reshape(B, S, D) @ wo

    def _B_ref(x, w_r, w_gate, w_up, w_down):
        B, S, D = x.shape
        C = 1
        r = x @ w_r
        idx = torch.argsort(-r, axis=-1)[:, :C]
        idx_e = (lambda x, n, axis: torch.repeat_interleave(x, n, dim=axis))(idx.reshape(B, C, 1), D, axis=2)
        x_sel = (lambda x, i, axis: torch.take_along_dim(x, i, dim=axis))(x, idx_e, axis=1)
        g = _silu(x_sel @ w_gate)
        u = x_sel @ w_up
        y = (g * u) @ w_down
        r_sel = _sigmoid((lambda x, i, axis: torch.take_along_dim(x, i, dim=axis))(r, idx, axis=1))
        y = y * r_sel.reshape(B, C, 1)
        b_off = (torch.arange(B) * S).reshape(B, 1)
        flat_idx = (idx + b_off).reshape(B * C)
        zero = (x * 0.0).reshape(B * S, D)
        upd = _scatter_add(zero, flat_idx, y.reshape(B * C, D), axis=0)
        return x + upd.reshape(B, S, D)

    x = A_x
    h = x + _A_ref(_layernorm(x, axis=-1), A_wqkv, A_wo)
    h2 = h + _B_ref(_layernorm(h, axis=-1), B_w_r, B_w_gate, B_w_up, B_w_down)
    return h2
```

```asm
; @launch grid=(256,1,1) block=(512,1,1) lds=160768
.amdgcn_target "amdgcn-amd-amdhsa--gfx950"
.text
.globl sequential_preLN__mha_block__moe_arch_mod__prompt_kernel
.p2align 8
.type sequential_preLN__mha_block__moe_arch_mod__prompt_kernel,@function
sequential_preLN__mha_block__moe_arch_mod__prompt_kernel:
    s_cmp_ge_u32 s2, 256
    s_cbranch_scc1 L_end
    s_load_dwordx4 s[4:7], s[0:1], 0
    s_load_dwordx4 s[8:11], s[0:1], 72
    s_getpc_b64 s[36:37]
L_pc:
    v_lshrrev_b32 v1, 6, v0
    v_and_b32 v2, 63, v0
    s_and_b32 s29, s2, 7
    v_readfirstlane_b32 s28, v1
    s_lshr_b32 s30, s2, 3
    s_lshr_b32 s56, s29, 1
    s_lshl_b32 s56, s56, 2
    s_and_b32 s33, s30, 3
    s_add_u32 s56, s56, s33
    s_lshl_b32 s49, s33, 1
    s_and_b32 s57, s29, 1
    s_lshl_b32 s57, s57, 3
    s_lshr_b32 s33, s30, 2
    s_add_u32 s57, s57, s33
    s_add_u32 s49, s49, s33
    s_and_b32 s45, s28, 3
    s_cmp_ge_u32 s28, 4
    s_cbranch_scc1 L_H
    v_lshrrev_b32 v4, 3, v2
    v_and_b32 v6, 7, v2
    v_lshrrev_b32 v5, 4, v2
    v_xor_b32 v5, v5, v6
    v_lshlrev_b32 v16, 10, v4
    v_lshl_add_u32 v16, v5, 4, v16
    v_xor_b32 v17, 64, v16
    s_lshl_b32 s40, s56, 17
    s_lshl_b32 s33, s45, 15
    s_add_u32 s40, s40, s33
    s_lshl_b32 s42, s45, 12
    s_add_u32 s42, s42, 8192
    s_mov_b32 s14, 0x200000
    s_mov_b32 s15, 0x00020000
    s_waitcnt lgkmcnt(0)
    s_mov_b32 s12, s4
    s_and_b32 s13, s5, 0xffff
    s_add_u32 s43, s49, 0
    s_and_b32 s43, s43, 7
    s_lshl_b32 s43, s43, 7
    s_add_u32 s43, s43, s40
    s_add_u32 m0, s42, 0
    s_add_u32 s41, s43, 0
    buffer_load_dwordx4 v16, s[12:15], s41 offen lds
    s_add_u32 m0, s42, 1024
    s_add_u32 s41, s43, 8192
    buffer_load_dwordx4 v17, s[12:15], s41 offen lds
    s_add_u32 m0, s42, 2048
    s_add_u32 s41, s43, 16384
    buffer_load_dwordx4 v16, s[12:15], s41 offen lds
    s_add_u32 m0, s42, 3072
    s_add_u32 s41, s43, 24576
    buffer_load_dwordx4 v17, s[12:15], s41 offen lds
    s_branch L_C
L_H:
    v_lshrrev_b32 v4, 3, v2
    v_bfe_u32 v5, v2, 4, 1
    v_lshlrev_b32 v5, 2, v5
    v_and_b32 v6, 7, v2
    v_xor_b32 v5, v5, v6
    v_mul_u32_u24 v21, 3072, v4
    v_lshl_add_u32 v21, v5, 4, v21
    s_mul_i32 s50, s45, 49152
    s_lshl_b32 s33, s57, 7
    s_add_u32 s51, s50, s33
    s_add_u32 s51, s51, 1024
    s_lshl_b32 s52, s45, 11
    s_mov_b32 s18, 0x180000
    s_mov_b32 s19, 0x00020000
    s_waitcnt lgkmcnt(0)
    s_mov_b32 s16, s6
    s_and_b32 s17, s7, 0xffff
    s_add_u32 s43, s49, 0
    s_and_b32 s43, s43, 7
    s_mul_i32 s43, s43, 196608
    s_add_u32 m0, s52, 0
    s_add_u32 s41, s43, s51
    buffer_load_dwordx4 v21, s[16:19], s41 offen lds
    s_add_u32 m0, s52, 1024
    s_add_u32 s41, s41, 24576
    buffer_load_dwordx4 v21, s[16:19], s41 offen lds
    v_lshlrev_b32 v117, 4, v2
    s_and_b32 s37, s37, 0xffff
    s_mov_b32 s38, code_end-L_pc
    s_mov_b32 s39, 0x00020000
    s_lshl_b32 s33, s30, 2
    s_add_u32 s33, s33, s45
    s_and_b32 s33, s33, 15
    s_lshl_b32 s33, s33, 11
    buffer_load_dwordx4 v[24:27], v117, s[36:39], s33 offen
    buffer_load_dwordx4 v[24:27], v117, s[36:39], s33 offen offset:1024
    s_add_u32 s43, s49, 1
    s_and_b32 s43, s43, 7
    s_mul_i32 s43, s43, 196608
    s_add_u32 m0, s52, 24576
    s_add_u32 s41, s43, s51
    buffer_load_dwordx4 v21, s[16:19], s41 offen lds
    s_add_u32 m0, s52, 25600
    s_add_u32 s41, s41, 24576
    buffer_load_dwordx4 v21, s[16:19], s41 offen lds
    s_add_u32 s43, s49, 2
    s_and_b32 s43, s43, 7
    s_mul_i32 s43, s43, 196608
    s_add_u32 m0, s52, 49152
    s_add_u32 s41, s43, s51
    buffer_load_dwordx4 v21, s[16:19], s41 offen lds
    s_add_u32 m0, s52, 50176
    s_add_u32 s41, s41, 24576
    buffer_load_dwordx4 v21, s[16:19], s41 offen lds
    v_lshrrev_b32 v4, 3, v2
    v_and_b32 v6, 7, v2
    v_lshrrev_b32 v5, 4, v2
    v_xor_b32 v5, v5, v6
    v_lshlrev_b32 v16, 10, v4
    v_lshl_add_u32 v16, v5, 4, v16
    v_xor_b32 v17, 64, v16
    s_lshl_b32 s40, s56, 17
    s_lshl_b32 s33, s45, 15
    s_add_u32 s40, s40, s33
    s_lshl_b32 s42, s45, 12
    s_add_u32 s42, s42, 8192
    s_mov_b32 s14, 0x200000
    s_mov_b32 s15, 0x00020000
    s_waitcnt lgkmcnt(0)
    s_mov_b32 s12, s4
    s_and_b32 s13, s5, 0xffff
    v_lshrrev_b32 v20, 2, v2
    v_mul_u32_u24 v20, 3072, v20
    v_and_b32 v6, 3, v2
    v_lshl_add_u32 v20, v6, 4, v20
    s_lshl_b32 s33, s57, 6
    s_add_u32 s50, s50, s33
    s_mov_b32 s24, s10
    s_and_b32 s25, s11, 0xffff
    s_mov_b32 s26, 0x1000000
    s_mov_b32 s27, 0x00020000
    s_mov_b32 s20, s8
    s_and_b32 s21, s9, 0xffff
    s_mov_b32 s22, 0x100
    s_mov_b32 s23, 0x00020000
    v_lshrrev_b32 v3, 5, v2
    v_bfe_u32 v5, v2, 2, 2
    v_bfe_u32 v6, v2, 4, 1
    v_lshlrev_b32 v8, 5, v6
    v_and_b32 v6, 3, v2
    v_lshl_add_u32 v8, v6, 3, v8
    v_lshl_add_u32 v8, v3, 9, v8
    v_lshl_add_u32 v8, v5, 6, v8
    v_and_b32 v116, 31, v2
    v_mov_b32 v18, 0x3f803f80
    v_mov_b32 v19, 0x3f803f80
    s_lshl_b32 s35, s45, 2
    s_add_u32 s44, s35, 0x20000
    s_lshl_b32 s53, s45, 10
    v_add_u32 v8, s53, v8
    v_add_u32 v8, 122880, v8
    v_lshlrev_b32 v9, 4, v116
    v_add_u32 v9, s44, v9
    v_lshlrev_b32 v4, 2, v2
    s_waitcnt vmcnt(6)
    s_barrier
    s_add_u32 s43, s49, 3
    s_and_b32 s43, s43, 7
    s_mul_i32 s43, s43, 196608
    s_add_u32 m0, s52, 73728
    s_add_u32 s41, s43, s51
    buffer_load_dwordx4 v21, s[16:19], s41 offen lds
    s_add_u32 m0, s52, 74752
    s_add_u32 s41, s41, 24576
    buffer_load_dwordx4 v21, s[16:19], s41 offen lds
    s_add_u32 s43, s49, 3
    s_and_b32 s43, s43, 7
    s_lshl_b32 s43, s43, 7
    s_add_u32 s43, s43, s40
    s_add_u32 m0, s42, 73728
    s_add_u32 s41, s43, 0
    buffer_load_dwordx4 v16, s[12:15], s41 offen lds
    s_add_u32 m0, s42, 74752
    s_add_u32 s41, s43, 8192
    buffer_load_dwordx4 v17, s[12:15], s41 offen lds
    s_add_u32 m0, s42, 75776
    s_add_u32 s41, s43, 16384
    buffer_load_dwordx4 v16, s[12:15], s41 offen lds
    s_add_u32 m0, s42, 76800
    s_add_u32 s41, s43, 24576
    buffer_load_dwordx4 v17, s[12:15], s41 offen lds
    s_waitcnt vmcnt(8)
    s_barrier
    s_add_u32 s43, s49, 4
    s_and_b32 s43, s43, 7
    s_mul_i32 s43, s43, 196608
    s_add_u32 m0, s52, 98304
    s_add_u32 s41, s43, s51
    buffer_load_dwordx4 v21, s[16:19], s41 offen lds
    s_add_u32 m0, s52, 99328
    s_add_u32 s41, s41, 24576
    buffer_load_dwordx4 v21, s[16:19], s41 offen lds
    s_add_u32 s43, s49, 4
    s_and_b32 s43, s43, 7
    s_lshl_b32 s43, s43, 7
    s_add_u32 s43, s43, s40
    s_add_u32 m0, s42, 98304
    s_add_u32 s41, s43, 0
    buffer_load_dwordx4 v16, s[12:15], s41 offen lds
    s_add_u32 m0, s42, 99328
    s_add_u32 s41, s43, 8192
    buffer_load_dwordx4 v17, s[12:15], s41 offen lds
    s_add_u32 m0, s42, 100352
    s_add_u32 s41, s43, 16384
    buffer_load_dwordx4 v16, s[12:15], s41 offen lds
    s_add_u32 m0, s42, 101376
    s_add_u32 s41, s43, 24576
    buffer_load_dwordx4 v17, s[12:15], s41 offen lds
    s_waitcnt vmcnt(12)
    s_barrier
    s_add_u32 s43, s49, 5
    s_and_b32 s43, s43, 7
    s_mul_i32 s43, s43, 196608
    s_add_u32 m0, s52, 0
    s_add_u32 s41, s43, s51
    buffer_load_dwordx4 v21, s[16:19], s41 offen lds
    s_add_u32 m0, s52, 1024
    s_add_u32 s41, s41, 24576
    buffer_load_dwordx4 v21, s[16:19], s41 offen lds
    s_add_u32 s43, s49, 5
    s_and_b32 s43, s43, 7
    s_lshl_b32 s43, s43, 7
    s_add_u32 s43, s43, s40
    s_add_u32 m0, s42, 0
    s_add_u32 s41, s43, 0
    buffer_load_dwordx4 v16, s[12:15], s41 offen lds
    s_add_u32 m0, s42, 1024
    s_add_u32 s41, s43, 8192
    buffer_load_dwordx4 v17, s[12:15], s41 offen lds
    s_add_u32 m0, s42, 2048
    s_add_u32 s41, s43, 16384
    buffer_load_dwordx4 v16, s[12:15], s41 offen lds
    s_add_u32 m0, s42, 3072
    s_add_u32 s41, s43, 24576
    buffer_load_dwordx4 v17, s[12:15], s41 offen lds
    s_waitcnt vmcnt(12)
    s_barrier
    s_add_u32 s43, s49, 6
    s_and_b32 s43, s43, 7
    s_mul_i32 s43, s43, 196608
    s_add_u32 m0, s52, 24576
    s_add_u32 s41, s43, s51
    buffer_load_dwordx4 v21, s[16:19], s41 offen lds
    s_add_u32 m0, s52, 25600
    s_add_u32 s41, s41, 24576
    buffer_load_dwordx4 v21, s[16:19], s41 offen lds
    s_add_u32 s43, s49, 6
    s_and_b32 s43, s43, 7
    s_lshl_b32 s43, s43, 7
    s_add_u32 s43, s43, s40
    s_add_u32 m0, s42, 24576
    s_add_u32 s41, s43, 0
    buffer_load_dwordx4 v16, s[12:15], s41 offen lds
    s_add_u32 m0, s42, 25600
    s_add_u32 s41, s43, 8192
    buffer_load_dwordx4 v17, s[12:15], s41 offen lds
    s_add_u32 m0, s42, 26624
    s_add_u32 s41, s43, 16384
    buffer_load_dwordx4 v16, s[12:15], s41 offen lds
    s_add_u32 m0, s42, 27648
    s_add_u32 s41, s43, 24576
    buffer_load_dwordx4 v17, s[12:15], s41 offen lds
    s_waitcnt vmcnt(12)
    s_barrier
    s_add_u32 s43, s49, 7
    s_and_b32 s43, s43, 7
    s_mul_i32 s43, s43, 196608
    s_add_u32 m0, s52, 49152
    s_add_u32 s41, s43, s51
    buffer_load_dwordx4 v21, s[16:19], s41 offen lds
    s_add_u32 m0, s52, 50176
    s_add_u32 s41, s41, 24576
    buffer_load_dwordx4 v21, s[16:19], s41 offen lds
    s_add_u32 s43, s49, 7
    s_and_b32 s43, s43, 7
    s_lshl_b32 s43, s43, 7
    s_add_u32 s43, s43, s40
    s_add_u32 m0, s42, 49152
    s_add_u32 s41, s43, 0
    buffer_load_dwordx4 v16, s[12:15], s41 offen lds
    s_add_u32 m0, s42, 50176
    s_add_u32 s41, s43, 8192
    buffer_load_dwordx4 v17, s[12:15], s41 offen lds
    s_add_u32 m0, s42, 51200
    s_add_u32 s41, s43, 16384
    buffer_load_dwordx4 v16, s[12:15], s41 offen lds
    s_add_u32 m0, s42, 52224
    s_add_u32 s41, s43, 24576
    buffer_load_dwordx4 v17, s[12:15], s41 offen lds
    s_add_u32 s43, s49, 0
    s_and_b32 s43, s43, 7
    s_mul_i32 s43, s43, 196608
    s_add_u32 m0, s53, 122880
    s_add_u32 s41, s43, s50
    buffer_load_dwordx4 v20, s[16:19], s41 offen lds
    s_add_u32 s43, s49, 1
    s_and_b32 s43, s43, 7
    s_mul_i32 s43, s43, 196608
    s_add_u32 m0, s53, 126976
    s_add_u32 s41, s43, s50
    buffer_load_dwordx4 v20, s[16:19], s41 offen lds
    s_add_u32 s43, s49, 2
    s_and_b32 s43, s43, 7
    s_mul_i32 s43, s43, 196608
    s_add_u32 m0, s53, 131072
    s_add_u32 s41, s43, s50
    buffer_load_dwordx4 v20, s[16:19], s41 offen lds
    s_add_u32 s43, s49, 3
    s_and_b32 s43, s43, 7
    s_mul_i32 s43, s43, 196608
    s_add_u32 m0, s53, 135168
    s_add_u32 s41, s43, s50
    buffer_load_dwordx4 v20, s[16:19], s41 offen lds
    s_waitcnt vmcnt(16)
    s_barrier
    s_add_u32 s43, s49, 4
    s_and_b32 s43, s43, 7
    s_mul_i32 s43, s43, 196608
    s_add_u32 m0, s53, 139264
    s_add_u32 s41, s43, s50
    buffer_load_dwordx4 v20, s[16:19], s41 offen lds
    s_add_u32 s43, s49, 5
    s_and_b32 s43, s43, 7
    s_mul_i32 s43, s43, 196608
    s_add_u32 m0, s53, 143360
    s_add_u32 s41, s43, s50
    buffer_load_dwordx4 v20, s[16:19], s41 offen lds
    s_add_u32 s43, s49, 6
    s_and_b32 s43, s43, 7
    s_mul_i32 s43, s43, 196608
    s_add_u32 m0, s53, 147456
    s_add_u32 s41, s43, s50
    buffer_load_dwordx4 v20, s[16:19], s41 offen lds
    s_add_u32 s43, s49, 7
    s_and_b32 s43, s43, 7
    s_mul_i32 s43, s43, 196608
    s_add_u32 m0, s53, 151552
    s_add_u32 s41, s43, s50
    buffer_load_dwordx4 v20, s[16:19], s41 offen lds
    s_waitcnt vmcnt(14)
    s_barrier
    s_waitcnt vmcnt(8)
    s_barrier
    s_waitcnt vmcnt(0)
    ds_read_b64_tr_b16 v[32:33], v8 offset:0
    ds_read_b64_tr_b16 v[34:35], v8 offset:256
    ds_read_b64_tr_b16 v[36:37], v8 offset:4096
    ds_read_b64_tr_b16 v[38:39], v8 offset:4352
    ds_read_b64_tr_b16 v[40:41], v8 offset:8192
    ds_read_b64_tr_b16 v[42:43], v8 offset:8448
    ds_read_b64_tr_b16 v[44:45], v8 offset:12288
    ds_read_b64_tr_b16 v[46:47], v8 offset:12544
    ds_read_b64_tr_b16 v[48:49], v8 offset:16384
    ds_read_b64_tr_b16 v[50:51], v8 offset:16640
    ds_read_b64_tr_b16 v[52:53], v8 offset:20480
    ds_read_b64_tr_b16 v[54:55], v8 offset:20736
    ds_read_b64_tr_b16 v[56:57], v8 offset:24576
    ds_read_b64_tr_b16 v[58:59], v8 offset:24832
    ds_read_b64_tr_b16 v[60:61], v8 offset:28672
    ds_read_b64_tr_b16 v[62:63], v8 offset:28928
    s_barrier
    s_waitcnt lgkmcnt(0)
    v_mfma_f32_4x4x4_16b_bf16 v[64:67], v[18:19], v[32:33], 0
    v_mfma_f32_4x4x4_16b_bf16 v[68:71], v[18:19], v[34:35], 0
    v_mfma_f32_4x4x4_16b_bf16 v[72:75], v[18:19], v[36:37], 0
    v_mfma_f32_4x4x4_16b_bf16 v[76:79], v[18:19], v[38:39], 0
    v_mfma_f32_4x4x4_16b_bf16 v[64:67], v[18:19], v[40:41], v[64:67]
    v_mfma_f32_4x4x4_16b_bf16 v[68:71], v[18:19], v[42:43], v[68:71]
    v_mfma_f32_4x4x4_16b_bf16 v[72:75], v[18:19], v[44:45], v[72:75]
    v_mfma_f32_4x4x4_16b_bf16 v[76:79], v[18:19], v[46:47], v[76:79]
    v_mfma_f32_4x4x4_16b_bf16 v[64:67], v[18:19], v[48:49], v[64:67]
    v_mfma_f32_4x4x4_16b_bf16 v[68:71], v[18:19], v[50:51], v[68:71]
    v_mfma_f32_4x4x4_16b_bf16 v[72:75], v[18:19], v[52:53], v[72:75]
    v_mfma_f32_4x4x4_16b_bf16 v[76:79], v[18:19], v[54:55], v[76:79]
    v_mfma_f32_4x4x4_16b_bf16 v[64:67], v[18:19], v[56:57], v[64:67]
    v_mfma_f32_4x4x4_16b_bf16 v[68:71], v[18:19], v[58:59], v[68:71]
    v_mfma_f32_4x4x4_16b_bf16 v[72:75], v[18:19], v[60:61], v[72:75]
    v_mfma_f32_4x4x4_16b_bf16 v[76:79], v[18:19], v[62:63], v[76:79]
    s_nop 4
    v_add_f32 v64, v64, v68
    v_add_f32 v72, v72, v76
    v_add_f32 v64, v64, v72
    v_mov_b32 v65, v64
    s_nop 1
    v_permlane32_swap_b32 v64, v65
    s_nop 0
    v_add_f32 v64, v64, v65
    ds_write_b32 v9, v64 offset:25600
    s_cmp_lg_u32 s28, 4
    s_cbranch_scc1 L_hJ
    s_mov_b32 s53, 0
L_ipoll:
    buffer_load_dword v5, v4, s[20:23], 0 offen sc1
    s_add_u32 s53, s53, 1
    s_waitcnt vmcnt(0)
    v_cmp_gt_u32 vcc, 4, v5
    s_cmp_gt_u32 s53, 200000
    s_cbranch_scc1 L_hJ
    s_cbranch_vccnz L_ipoll
L_hJ:
    s_waitcnt lgkmcnt(0)
    s_barrier
    s_cmp_lg_u32 s28, 4
    s_cbranch_scc1 L_P2
    v_add_u32 v4, 0x26e00, v117
    s_mov_b64 exec, 3
    ds_read_b128 v[8:11], v4
    s_lshl_b32 s33, s57, 11
    s_lshl_b32 s34, s56, 7
    s_add_u32 s33, s33, s34
    s_add_u32 s33, s33, 0xac2000
    s_waitcnt lgkmcnt(0)
    v_min_u32 v8, 0x7fffffff, v8
    buffer_store_dwordx4 v[8:11], v117, s[24:27], s33 offen sc1
    s_mov_b64 exec, -1
    s_branch L_P2
L_C:
    s_add_u32 s43, s49, 1
    s_and_b32 s43, s43, 7
    s_lshl_b32 s43, s43, 7
    s_add_u32 s43, s43, s40
    s_add_u32 m0, s42, 24576
    s_add_u32 s41, s43, 0
    buffer_load_dwordx4 v16, s[12:15], s41 offen lds
    s_add_u32 m0, s42, 25600
    s_add_u32 s41, s43, 8192
    buffer_load_dwordx4 v17, s[12:15], s41 offen lds
    s_add_u32 m0, s42, 26624
    s_add_u32 s41, s43, 16384
    buffer_load_dwordx4 v16, s[12:15], s41 offen lds
    s_add_u32 m0, s42, 27648
    s_add_u32 s41, s43, 24576
    buffer_load_dwordx4 v17, s[12:15], s41 offen lds
    s_add_u32 s43, s49, 2
    s_and_b32 s43, s43, 7
    s_lshl_b32 s43, s43, 7
    s_add_u32 s43, s43, s40
    s_add_u32 m0, s42, 49152
    s_add_u32 s41, s43, 0
    buffer_load_dwordx4 v16, s[12:15], s41 offen lds
    s_add_u32 m0, s42, 50176
    s_add_u32 s41, s43, 8192
    buffer_load_dwordx4 v17, s[12:15], s41 offen lds
    s_add_u32 m0, s42, 51200
    s_add_u32 s41, s43, 16384
    buffer_load_dwordx4 v16, s[12:15], s41 offen lds
    s_add_u32 m0, s42, 52224
    s_add_u32 s41, s43, 24576
    buffer_load_dwordx4 v17, s[12:15], s41 offen lds
    v_lshlrev_b32 v117, 4, v2
    v_lshrrev_b32 v3, 5, v2
    v_bfe_u32 v5, v2, 2, 2
    v_bfe_u32 v6, v2, 4, 1
    v_lshlrev_b32 v4, 5, v6
    v_and_b32 v6, 3, v2
    v_lshl_add_u32 v4, v6, 3, v4
    v_lshl_add_u32 v4, v3, 9, v4
    v_lshl_add_u32 v4, v5, 6, v4
    v_and_b32 v116, 31, v2
    v_mov_b32 v18, 0x3f803f80
    v_mov_b32 v19, 0x3f803f80
    s_lshl_b32 s35, s45, 2
    s_add_u32 s44, s35, 0x20000
    v_and_b32 v113, 63, v4
    v_lshl_add_u32 v113, v3, 10, v113
    v_lshl_add_u32 v113, v5, 7, v113
    v_bfe_u32 v6, v2, 3, 1
    v_lshl_add_u32 v113, v6, 6, v113
    v_bfe_u32 v6, v2, 1, 3
    v_xor_b32 v6, v6, v3
    v_lshlrev_b32 v5, 7, v116
    v_add_u32 v5, s42, v5
    s_add_u32 s33, s45, 0
    s_and_b32 s33, s33, 3
    s_lshl_b32 s35, s33, 11
    s_lshl_b32 s34, s33, 1
    v_add_u32 v8, s35, v113
    s_lshl_b32 s35, s33, 10
    s_add_u32 s35, s35, 122880
    v_add_u32 v108, s35, v4
    v_xor_b32 v7, s34, v6
    v_lshl_add_u32 v12, v7, 4, v5
    s_add_u32 s33, s45, 1
    s_and_b32 s33, s33, 3
    s_lshl_b32 s35, s33, 11
    s_lshl_b32 s34, s33, 1
    v_add_u32 v9, s35, v113
    s_lshl_b32 s35, s33, 10
    s_add_u32 s35, s35, 122880
    v_add_u32 v109, s35, v4
    v_xor_b32 v7, s34, v6
    v_lshl_add_u32 v13, v7, 4, v5
    s_add_u32 s33, s45, 2
    s_and_b32 s33, s33, 3
    s_lshl_b32 s35, s33, 11
    s_lshl_b32 s34, s33, 1
    v_add_u32 v10, s35, v113
    s_lshl_b32 s35, s33, 10
    s_add_u32 s35, s35, 122880
    v_add_u32 v110, s35, v4
    v_xor_b32 v7, s34, v6
    v_lshl_add_u32 v14, v7, 4, v5
    s_add_u32 s33, s45, 3
    s_and_b32 s33, s33, 3
    s_lshl_b32 s35, s33, 11
    s_lshl_b32 s34, s33, 1
    v_add_u32 v11, s35, v113
    s_lshl_b32 s35, s33, 10
    s_add_u32 s35, s35, 122880
    v_add_u32 v111, s35, v4
    v_xor_b32 v7, s34, v6
    v_lshl_add_u32 v15, v7, 4, v5
    s_mov_b32 s24, s10
    s_and_b32 s25, s11, 0xffff
    s_mov_b32 s26, 0x1000000
    s_mov_b32 s27, 0x00020000
    s_mov_b32 s20, s8
    s_and_b32 s21, s9, 0xffff
    s_mov_b32 s22, 0x100
    s_mov_b32 s23, 0x00020000
    v_mov_b32 v48, -1
    v_mov_b32 v49, -1
    v_mov_b32 v50, -1
    v_mov_b32 v51, -1
    s_mul_i32 s34, s2, 12288
    s_mul_i32 s35, s45, 3072
    s_add_u32 s34, s34, s35
    s_add_u32 s34, s34, 0x800000
    buffer_store_dwordx4 v[48:51], v117, s[24:27], s34 offen offset:0 sc1
    buffer_store_dwordx4 v[48:51], v117, s[24:27], s34 offen offset:1024 sc1
    buffer_store_dwordx4 v[48:51], v117, s[24:27], s34 offen offset:2048 sc1
    s_lshl_b32 s33, s45, 9
    v_lshlrev_b32 v118, 4, v3
    v_add_u32 v118, 0x20000, v118
    v_add_u32 v118, s33, v118
    v_lshlrev_b32 v119, 2, v2
    v_add_u32 v119, 0x20000, v119
    v_add_u32 v119, s33, v119
    v_lshlrev_b32 v120, 5, v116
    v_lshl_add_u32 v120, v3, 4, v120
    s_lshl_b32 s46, s57, 18
    s_lshl_b32 s34, s56, 12
    s_add_u32 s46, s46, s34
    s_lshl_b32 s35, s45, 10
    s_add_u32 s46, s46, s35
    s_add_u32 s46, s46, 0x200000
    s_add_u32 s47, s46, 0x10000
    s_add_u32 s48, s46, 0x20000
    s_add_u32 s62, s46, 0x30000
    v_add_u32 v112, s35, v117
    s_mul_i32 s33, s45, 4608
    v_mul_u32_u24 v124, 72, v116
    v_lshl_add_u32 v124, v3, 3, v124
    v_add_u32 v124, s33, v124
    v_bfe_u32 v125, v2, 2, 2
    v_lshl_add_u32 v125, v3, 3, v125
    v_mul_u32_u24 v125, 72, v125
    v_bfe_u32 v6, v2, 4, 1
    v_lshl_add_u32 v125, v6, 5, v125
    v_and_b32 v5, 1, v2
    v_lshl_add_u32 v125, v5, 4, v125
    v_bfe_u32 v5, v2, 1, 1
    v_lshl_add_u32 v125, v5, 3, v125
    v_add_u32 v125, s33, v125
    v_and_b32 v126, 15, v2
    v_lshlrev_b32 v126, 4, v126
    v_lshl_add_u32 v126, v3, 8, v126
    v_lshl_add_u32 v126, v6, 16, v126
    v_add_u32 v121, s44, v117
    v_lshlrev_b32 v123, 4, v116
    v_add_u32 v123, 0x20000, v123
    v_add_u32 v127, 0x20000, v117
    v_mov_b32 v122, s44
    v_and_b32 v5, 3, v2
    v_cmp_eq_u32 s[50:51], 1, v5
    v_cmp_eq_u32 s[52:53], 2, v5
    v_cmp_eq_u32 s[54:55], 3, v5
    s_mov_b32 s60, 0
    s_mov_b32 s61, 0x80000000
    s_waitcnt vmcnt(11)
    s_barrier
    ds_read_b128 v[128:131], v12 offset:0
    ds_read_b64_tr_b16 v[52:53], v8 offset:0
    v_xor_b32 v7, 64, v8
    ds_read_b64_tr_b16 v[54:55], v8 offset:512
    ds_read_b64_tr_b16 v[56:57], v7 offset:0
    ds_read_b64_tr_b16 v[58:59], v7 offset:512
    ds_read_b128 v[132:135], v13 offset:0
    ds_read_b64_tr_b16 v[60:61], v9 offset:0
    v_xor_b32 v7, 64, v9
    ds_read_b64_tr_b16 v[62:63], v9 offset:512
    ds_read_b64_tr_b16 v[64:65], v7 offset:0
    ds_read_b64_tr_b16 v[66:67], v7 offset:512
    s_waitcnt lgkmcnt(5)
    v_mfma_f32_32x32x16_bf16 v[76:91], v[52:55], v[128:131], 0
    ds_read_b128 v[136:139], v14 offset:0
    ds_read_b64_tr_b16 v[68:69], v10 offset:0
    v_xor_b32 v7, 64, v10
    ds_read_b64_tr_b16 v[70:71], v10 offset:512
    v_mfma_f32_32x32x16_bf16 v[92:107], v[56:59], v[128:131], 0
    ds_read_b64_tr_b16 v[72:73], v7 offset:0
    ds_read_b64_tr_b16 v[74:75], v7 offset:512
    s_waitcnt lgkmcnt(5)
    v_mfma_f32_32x32x16_bf16 v[76:91], v[60:63], v[132:135], v[76:91]
    ds_read_b128 v[140:143], v15 offset:0
    ds_read_b64_tr_b16 v[52:53], v11 offset:0
    v_xor_b32 v7, 64, v11
    ds_read_b64_tr_b16 v[54:55], v11 offset:512
    v_mfma_f32_32x32x16_bf16 v[92:107], v[64:67], v[132:135], v[92:107]
    ds_read_b64_tr_b16 v[56:57], v7 offset:0
    ds_read_b64_tr_b16 v[58:59], v7 offset:512
    s_waitcnt vmcnt(7)
    s_barrier
    s_waitcnt lgkmcnt(5)
    v_mfma_f32_32x32x16_bf16 v[76:91], v[68:71], v[136:139], v[76:91]
    ds_read_b128 v[144:147], v12 offset:24576
    ds_read_b64_tr_b16 v[60:61], v8 offset:24576
    v_xor_b32 v7, 64, v8
    ds_read_b64_tr_b16 v[62:63], v8 offset:25088
    v_mfma_f32_32x32x16_bf16 v[92:107], v[72:75], v[136:139], v[92:107]
    ds_read_b64_tr_b16 v[64:65], v7 offset:24576
    ds_read_b64_tr_b16 v[66:67], v7 offset:25088
    s_waitcnt lgkmcnt(5)
    v_mfma_f32_32x32x16_bf16 v[76:91], v[52:55], v[140:143], v[76:91]
    ds_read_b128 v[148:151], v13 offset:24576
    ds_read_b64_tr_b16 v[68:69], v9 offset:24576
    v_xor_b32 v7, 64, v9
    ds_read_b64_tr_b16 v[70:71], v9 offset:25088
    v_mfma_f32_32x32x16_bf16 v[92:107], v[56:59], v[140:143], v[92:107]
    ds_read_b64_tr_b16 v[72:73], v7 offset:24576
    ds_read_b64_tr_b16 v[74:75], v7 offset:25088
    v_mfma_f32_4x4x4_16b_bf16 v[24:27], v[18:19], v[128:129], 0
    v_mfma_f32_4x4x4_16b_bf16 v[32:35], v[128:129], v[128:129], 0
    v_mfma_f32_4x4x4_16b_bf16 v[40:43], v[18:19], v[52:53], 0
    v_mfma_f32_4x4x4_16b_bf16 v[28:31], v[18:19], v[130:131], 0
    v_mfma_f32_4x4x4_16b_bf16 v[36:39], v[130:131], v[130:131], 0
    v_mfma_f32_4x4x4_16b_bf16 v[44:47], v[18:19], v[56:57], 0
    v_mfma_f32_4x4x4_16b_bf16 v[24:27], v[18:19], v[132:133], v[24:27]
    v_mfma_f32_4x4x4_16b_bf16 v[32:35], v[132:133], v[132:133], v[32:35]
    v_mfma_f32_4x4x4_16b_bf16 v[40:43], v[18:19], v[54:55], v[40:43]
    v_mfma_f32_4x4x4_16b_bf16 v[28:31], v[18:19], v[134:135], v[28:31]
    v_mfma_f32_4x4x4_16b_bf16 v[36:39], v[134:135], v[134:135], v[36:39]
    v_mfma_f32_4x4x4_16b_bf16 v[44:47], v[18:19], v[58:59], v[44:47]
    v_mfma_f32_4x4x4_16b_bf16 v[24:27], v[18:19], v[136:137], v[24:27]
    v_mfma_f32_4x4x4_16b_bf16 v[32:35], v[136:137], v[136:137], v[32:35]
    v_mfma_f32_4x4x4_16b_bf16 v[28:31], v[18:19], v[138:139], v[28:31]
    v_mfma_f32_4x4x4_16b_bf16 v[36:39], v[138:139], v[138:139], v[36:39]
    v_mfma_f32_4x4x4_16b_bf16 v[24:27], v[18:19], v[140:141], v[24:27]
    v_mfma_f32_4x4x4_16b_bf16 v[32:35], v[140:141], v[140:141], v[32:35]
    v_mfma_f32_4x4x4_16b_bf16 v[28:31], v[18:19], v[142:143], v[28:31]
    v_mfma_f32_4x4x4_16b_bf16 v[36:39], v[142:143], v[142:143], v[36:39]
    s_waitcnt lgkmcnt(5)
    v_mfma_f32_32x32x16_bf16 v[76:91], v[60:63], v[144:147], v[76:91]
    ds_read_b128 v[152:155], v14 offset:24576
    ds_read_b64_tr_b16 v[52:53], v10 offset:24576
    v_xor_b32 v7, 64, v10
    ds_read_b64_tr_b16 v[54:55], v10 offset:25088
    v_mfma_f32_32x32x16_bf16 v[92:107], v[64:67], v[144:147], v[92:107]
    ds_read_b64_tr_b16 v[56:57], v7 offset:24576
    ds_read_b64_tr_b16 v[58:59], v7 offset:25088
    s_waitcnt lgkmcnt(5)
    v_mfma_f32_32x32x16_bf16 v[76:91], v[68:71], v[148:151], v[76:91]
    ds_read_b128 v[156:159], v15 offset:24576
    ds_read_b64_tr_b16 v[60:61], v11 offset:24576
    v_xor_b32 v7, 64, v11
    ds_read_b64_tr_b16 v[62:63], v11 offset:25088
    v_mfma_f32_32x32x16_bf16 v[92:107], v[72:75], v[148:151], v[92:107]
    ds_read_b64_tr_b16 v[64:65], v7 offset:24576
    ds_read_b64_tr_b16 v[66:67], v7 offset:25088
    s_waitcnt vmcnt(3)
    s_barrier
    v_add_u32 v8, 0xc000, v8
    v_add_u32 v9, 0xc000, v9
    v_add_u32 v10, 0xc000, v10
    v_add_u32 v11, 0xc000, v11
    v_add_u32 v12, 0xc000, v12
    v_add_u32 v13, 0xc000, v13
    v_add_u32 v14, 0xc000, v14
    v_add_u32 v15, 0xc000, v15
    s_waitcnt lgkmcnt(5)
    v_mfma_f32_32x32x16_bf16 v[76:91], v[52:55], v[152:155], v[76:91]
    ds_read_b128 v[160:163], v12 offset:0
    ds_read_b64_tr_b16 v[68:69], v8 offset:0
    v_xor_b32 v7, 64, v8
    ds_read_b64_tr_b16 v[70:71], v8 offset:512
    v_mfma_f32_32x32x16_bf16 v[92:107], v[56:59], v[152:155], v[92:107]
    ds_read_b64_tr_b16 v[72:73], v7 offset:0
    ds_read_b64_tr_b16 v[74:75], v7 offset:512
    s_waitcnt lgkmcnt(5)
    v_mfma_f32_32x32x16_bf16 v[76:91], v[60:63], v[156:159], v[76:91]
    ds_read_b128 v[164:167], v13 offset:0
    ds_read_b64_tr_b16 v[52:53], v9 offset:0
    v_xor_b32 v7, 64, v9
    ds_read_b64_tr_b16 v[54:55], v9 offset:512
    v_mfma_f32_32x32x16_bf16 v[92:107], v[64:67], v[156:159], v[92:107]
    ds_read_b64_tr_b16 v[56:57], v7 offset:0
    ds_read_b64_tr_b16 v[58:59], v7 offset:512
    v_mfma_f32_4x4x4_16b_bf16 v[24:27], v[18:19], v[144:145], v[24:27]
    v_mfma_f32_4x4x4_16b_bf16 v[32:35], v[144:145], v[144:145], v[32:35]
    v_mfma_f32_4x4x4_16b_bf16 v[40:43], v[18:19], v[60:61], v[40:43]
    v_mfma_f32_4x4x4_16b_bf16 v[28:31], v[18:19], v[146:147], v[28:31]
    v_mfma_f32_4x4x4_16b_bf16 v[36:39], v[146:147], v[146:147], v[36:39]
    v_mfma_f32_4x4x4_16b_bf16 v[44:47], v[18:19], v[64:65], v[44:47]
    v_mfma_f32_4x4x4_16b_bf16 v[24:27], v[18:19], v[148:149], v[24:27]
    v_mfma_f32_4x4x4_16b_bf16 v[32:35], v[148:149], v[148:149], v[32:35]
    v_mfma_f32_4x4x4_16b_bf16 v[40:43], v[18:19], v[62:63], v[40:43]
    v_mfma_f32_4x4x4_16b_bf16 v[28:31], v[18:19], v[150:151], v[28:31]
    v_mfma_f32_4x4x4_16b_bf16 v[36:39], v[150:151], v[150:151], v[36:39]
    v_mfma_f32_4x4x4_16b_bf16 v[44:47], v[18:19], v[66:67], v[44:47]
    v_mfma_f32_4x4x4_16b_bf16 v[24:27], v[18:19], v[152:153], v[24:27]
    v_mfma_f32_4x4x4_16b_bf16 v[32:35], v[152:153], v[152:153], v[32:35]
    v_mfma_f32_4x4x4_16b_bf16 v[28:31], v[18:19], v[154:155], v[28:31]
    v_mfma_f32_4x4x4_16b_bf16 v[36:39], v[154:155], v[154:155], v[36:39]
    v_mfma_f32_4x4x4_16b_bf16 v[24:27], v[18:19], v[156:157], v[24:27]
    v_mfma_f32_4x4x4_16b_bf16 v[32:35], v[156:157], v[156:157], v[32:35]
    v_mfma_f32_4x4x4_16b_bf16 v[28:31], v[18:19], v[158:159], v[28:31]
    v_mfma_f32_4x4x4_16b_bf16 v[36:39], v[158:159], v[158:159], v[36:39]
    s_waitcnt lgkmcnt(5)
    v_mfma_f32_32x32x16_bf16 v[76:91], v[68:71], v[160:163], v[76:91]
    ds_read_b128 v[168:171], v14 offset:0
    ds_read_b64_tr_b16 v[60:61], v10 offset:0
    v_xor_b32 v7, 64, v10
    ds_read_b64_tr_b16 v[62:63], v10 offset:512
    v_mfma_f32_32x32x16_bf16 v[92:107], v[72:75], v[160:163], v[92:107]
    ds_read_b64_tr_b16 v[64:65], v7 offset:0
    ds_read_b64_tr_b16 v[66:67], v7 offset:512
    s_waitcnt lgkmcnt(5)
    v_mfma_f32_32x32x16_bf16 v[76:91], v[52:55], v[164:167], v[76:91]
    ds_read_b128 v[172:175], v15 offset:0
    ds_read_b64_tr_b16 v[68:69], v11 offset:0
    v_xor_b32 v7, 64, v11
    ds_read_b64_tr_b16 v[70:71], v11 offset:512
    v_mfma_f32_32x32x16_bf16 v[92:107], v[56:59], v[164:167], v[92:107]
    ds_read_b64_tr_b16 v[72:73], v7 offset:0
    ds_read_b64_tr_b16 v[74:75], v7 offset:512
    s_waitcnt vmcnt(0)
    s_barrier
    s_cmp_lg_u32 s28, 0
    s_cbranch_scc1 L_noinc
    v_mov_b32 v4, 0
    v_mov_b32 v5, 1
    s_and_b32 s33, s2, 63
    s_lshl_b32 s33, s33, 2
    s_mov_b64 exec, 1
    buffer_atomic_add v5, v4, s[20:23], s33 offen sc1
    s_mov_b64 exec, -1
L_noinc:
    s_waitcnt lgkmcnt(5)
    v_mfma_f32_32x32x16_bf16 v[76:91], v[60:63], v[168:171], v[76:91]
    ds_read_b128 v[176:179], v12 offset:24576
    ds_read_b64_tr_b16 v[52:53], v8 offset:24576
    v_xor_b32 v7, 64, v8
    ds_read_b64_tr_b16 v[54:55], v8 offset:25088
    v_mfma_f32_32x32x16_bf16 v[92:107], v[64:67], v[168:171], v[92:107]
    ds_read_b64_tr_b16 v[56:57], v7 offset:24576
    ds_read_b64_tr_b16 v[58:59], v7 offset:25088
    s_waitcnt lgkmcnt(5)
    v_mfma_f32_32x32x16_bf16 v[76:91], v[68:71], v[172:175], v[76:91]
    ds_read_b128 v[180:183], v13 offset:24576
    ds_read_b64_tr_b16 v[60:61], v9 offset:24576
    v_xor_b32 v7, 64, v9
    ds_read_b64_tr_b16 v[62:63], v9 offset:25088
    v_mfma_f32_32x32x16_bf16 v[92:107], v[72:75], v[172:175], v[92:107]
    ds_read_b64_tr_b16 v[64:65], v7 offset:24576
    ds_read_b64_tr_b16 v[66:67], v7 offset:25088
    v_mfma_f32_4x4x4_16b_bf16 v[24:27], v[18:19], v[160:161], v[24:27]
    v_mfma_f32_4x4x4_16b_bf16 v[32:35], v[160:161], v[160:161], v[32:35]
    v_mfma_f32_4x4x4_16b_bf16 v[40:43], v[18:19], v[68:69], v[40:43]
    v_mfma_f32_4x4x4_16b_bf16 v[28:31], v[18:19], v[162:163], v[28:31]
    v_mfma_f32_4x4x4_16b_bf16 v[36:39], v[162:163], v[162:163], v[36:39]
    v_mfma_f32_4x4x4_16b_bf16 v[44:47], v[18:19], v[72:73], v[44:47]
    v_mfma_f32_4x4x4_16b_bf16 v[24:27], v[18:19], v[164:165], v[24:27]
    v_mfma_f32_4x4x4_16b_bf16 v[32:35], v[164:165], v[164:165], v[32:35]
    v_mfma_f32_4x4x4_16b_bf16 v[40:43], v[18:19], v[70:71], v[40:43]
    v_mfma_f32_4x4x4_16b_bf16 v[28:31], v[18:19], v[166:167], v[28:31]
    v_mfma_f32_4x4x4_16b_bf16 v[36:39], v[166:167], v[166:167], v[36:39]
    v_mfma_f32_4x4x4_16b_bf16 v[44:47], v[18:19], v[74:75], v[44:47]
    v_mfma_f32_4x4x4_16b_bf16 v[24:27], v[18:19], v[168:169], v[24:27]
    v_mfma_f32_4x4x4_16b_bf16 v[32:35], v[168:169], v[168:169], v[32:35]
    v_mfma_f32_4x4x4_16b_bf16 v[28:31], v[18:19], v[170:171], v[28:31]
    v_mfma_f32_4x4x4_16b_bf16 v[36:39], v[170:171], v[170:171], v[36:39]
    v_mfma_f32_4x4x4_16b_bf16 v[24:27], v[18:19], v[172:173], v[24:27]
    v_mfma_f32_4x4x4_16b_bf16 v[32:35], v[172:173], v[172:173], v[32:35]
    v_mfma_f32_4x4x4_16b_bf16 v[28:31], v[18:19], v[174:175], v[28:31]
    v_mfma_f32_4x4x4_16b_bf16 v[36:39], v[174:175], v[174:175], v[36:39]
    s_waitcnt lgkmcnt(5)
    v_mfma_f32_32x32x16_bf16 v[76:91], v[52:55], v[176:179], v[76:91]
    ds_read_b128 v[184:187], v14 offset:24576
    ds_read_b64_tr_b16 v[68:69], v10 offset:24576
    v_xor_b32 v7, 64, v10
    ds_read_b64_tr_b16 v[70:71], v10 offset:25088
    v_mfma_f32_32x32x16_bf16 v[92:107], v[56:59], v[176:179], v[92:107]
    ds_read_b64_tr_b16 v[72:73], v7 offset:24576
    ds_read_b64_tr_b16 v[74:75], v7 offset:25088
    s_waitcnt lgkmcnt(5)
    v_mfma_f32_32x32x16_bf16 v[76:91], v[60:63], v[180:183], v[76:91]
    ds_read_b128 v[188:191], v15 offset:24576
    ds_read_b64_tr_b16 v[52:53], v11 offset:24576
    v_xor_b32 v7, 64, v11
    ds_read_b64_tr_b16 v[54:55], v11 offset:25088
    v_mfma_f32_32x32x16_bf16 v[92:107], v[64:67], v[180:183], v[92:107]
    ds_read_b64_tr_b16 v[56:57], v7 offset:24576
    ds_read_b64_tr_b16 v[58:59], v7 offset:25088
    s_barrier
    v_add_u32 v8, 0xc000, v8
    v_add_u32 v9, 0xc000, v9
    v_add_u32 v10, 0xc000, v10
    v_add_u32 v11, 0xc000, v11
    v_add_u32 v12, 0xc000, v12
    v_add_u32 v13, 0xc000, v13
    v_add_u32 v14, 0xc000, v14
    v_add_u32 v15, 0xc000, v15
    s_waitcnt lgkmcnt(5)
    v_mfma_f32_32x32x16_bf16 v[76:91], v[68:71], v[184:187], v[76:91]
    ds_read_b128 v[192:195], v12 offset:0
    ds_read_b64_tr_b16 v[60:61], v8 offset:0
    v_xor_b32 v7, 64, v8
    ds_read_b64_tr_b16 v[62:63], v8 offset:512
    v_mfma_f32_32x32x16_bf16 v[92:107], v[72:75], v[184:187], v[92:107]
    ds_read_b64_tr_b16 v[64:65], v7 offset:0
    ds_read_b64_tr_b16 v[66:67], v7 offset:512
    s_waitcnt lgkmcnt(5)
    v_mfma_f32_32x32x16_bf16 v[76:91], v[52:55], v[188:191], v[76:91]
    ds_read_b128 v[196:199], v13 offset:0
    ds_read_b64_tr_b16 v[68:69], v9 offset:0
    v_xor_b32 v7, 64, v9
    ds_read_b64_tr_b16 v[70:71], v9 offset:512
    v_mfma_f32_32x32x16_bf16 v[92:107], v[56:59], v[188:191], v[92:107]
    ds_read_b64_tr_b16 v[72:73], v7 offset:0
    ds_read_b64_tr_b16 v[74:75], v7 offset:512
    v_mfma_f32_4x4x4_16b_bf16 v[24:27], v[18:19], v[176:177], v[24:27]
    v_mfma_f32_4x4x4_16b_bf16 v[32:35], v[176:177], v[176:177], v[32:35]
    v_mfma_f32_4x4x4_16b_bf16 v[40:43], v[18:19], v[52:53], v[40:43]
    v_mfma_f32_4x4x4_16b_bf16 v[28:31], v[18:19], v[178:179], v[28:31]
    v_mfma_f32_4x4x4_16b_bf16 v[36:39], v[178:179], v[178:179], v[36:39]
    v_mfma_f32_4x4x4_16b_bf16 v[44:47], v[18:19], v[56:57], v[44:47]
    v_mfma_f32_4x4x4_16b_bf16 v[24:27], v[18:19], v[180:181], v[24:27]
    v_mfma_f32_4x4x4_16b_bf16 v[32:35], v[180:181], v[180:181], v[32:35]
    v_mfma_f32_4x4x4_16b_bf16 v[40:43], v[18:19], v[54:55], v[40:43]
    v_mfma_f32_4x4x4_16b_bf16 v[28:31], v[18:19], v[182:183], v[28:31]
    v_mfma_f32_4x4x4_16b_bf16 v[36:39], v[182:183], v[182:183], v[36:39]
    v_mfma_f32_4x4x4_16b_bf16 v[44:47], v[18:19], v[58:59], v[44:47]
    v_mfma_f32_4x4x4_16b_bf16 v[24:27], v[18:19], v[184:185], v[24:27]
    v_mfma_f32_4x4x4_16b_bf16 v[32:35], v[184:185], v[184:185], v[32:35]
    v_mfma_f32_4x4x4_16b_bf16 v[28:31], v[18:19], v[186:187], v[28:31]
    v_mfma_f32_4x4x4_16b_bf16 v[36:39], v[186:187], v[186:187], v[36:39]
    v_mfma_f32_4x4x4_16b_bf16 v[24:27], v[18:19], v[188:189], v[24:27]
    v_mfma_f32_4x4x4_16b_bf16 v[32:35], v[188:189], v[188:189], v[32:35]
    v_mfma_f32_4x4x4_16b_bf16 v[28:31], v[18:19], v[190:191], v[28:31]
    v_mfma_f32_4x4x4_16b_bf16 v[36:39], v[190:191], v[190:191], v[36:39]
    s_waitcnt lgkmcnt(5)
    v_mfma_f32_32x32x16_bf16 v[76:91], v[60:63], v[192:195], v[76:91]
    ds_read_b128 v[200:203], v14 offset:0
    ds_read_b64_tr_b16 v[52:53], v10 offset:0
    v_xor_b32 v7, 64, v10
    ds_read_b64_tr_b16 v[54:55], v10 offset:512
    v_mfma_f32_32x32x16_bf16 v[92:107], v[64:67], v[192:195], v[92:107]
    ds_read_b64_tr_b16 v[56:57], v7 offset:0
    ds_read_b64_tr_b16 v[58:59], v7 offset:512
    s_waitcnt lgkmcnt(5)
    v_mfma_f32_32x32x16_bf16 v[76:91], v[68:71], v[196:199], v[76:91]
    ds_read_b128 v[204:207], v15 offset:0
    ds_read_b64_tr_b16 v[60:61], v11 offset:0
    v_xor_b32 v7, 64, v11
    ds_read_b64_tr_b16 v[62:63], v11 offset:512
    v_mfma_f32_32x32x16_bf16 v[92:107], v[72:75], v[196:199], v[92:107]
    ds_read_b64_tr_b16 v[64:65], v7 offset:0
    ds_read_b64_tr_b16 v[66:67], v7 offset:512
    s_barrier
    v_add_u32 v8, 0xfffe8000, v8
    v_add_u32 v9, 0xfffe8000, v9
    v_add_u32 v10, 0xfffe8000, v10
    v_add_u32 v11, 0xfffe8000, v11
    v_add_u32 v12, 0xfffe8000, v12
    v_add_u32 v13, 0xfffe8000, v13
    v_add_u32 v14, 0xfffe8000, v14
    v_add_u32 v15, 0xfffe8000, v15
    s_waitcnt lgkmcnt(5)
    v_mfma_f32_32x32x16_bf16 v[76:91], v[52:55], v[200:203], v[76:91]
    ds_read_b128 v[208:211], v12 offset:0
    ds_read_b64_tr_b16 v[68:69], v8 offset:0
    v_xor_b32 v7, 64, v8
    ds_read_b64_tr_b16 v[70:71], v8 offset:512
    v_mfma_f32_32x32x16_bf16 v[92:107], v[56:59], v[200:203], v[92:107]
    ds_read_b64_tr_b16 v[72:73], v7 offset:0
    ds_read_b64_tr_b16 v[74:75], v7 offset:512
    s_waitcnt lgkmcnt(5)
    v_mfma_f32_32x32x16_bf16 v[76:91], v[60:63], v[204:207], v[76:91]
    ds_read_b128 v[212:215], v13 offset:0
    ds_read_b64_tr_b16 v[52:53], v9 offset:0
    v_xor_b32 v7, 64, v9
    ds_read_b64_tr_b16 v[54:55], v9 offset:512
    v_mfma_f32_32x32x16_bf16 v[92:107], v[64:67], v[204:207], v[92:107]
    ds_read_b64_tr_b16 v[56:57], v7 offset:0
    ds_read_b64_tr_b16 v[58:59], v7 offset:512
    v_mfma_f32_4x4x4_16b_bf16 v[24:27], v[18:19], v[192:193], v[24:27]
    v_mfma_f32_4x4x4_16b_bf16 v[32:35], v[192:193], v[192:193], v[32:35]
    v_mfma_f32_4x4x4_16b_bf16 v[40:43], v[18:19], v[60:61], v[40:43]
    v_mfma_f32_4x4x4_16b_bf16 v[28:31], v[18:19], v[194:195], v[28:31]
    v_mfma_f32_4x4x4_16b_bf16 v[36:39], v[194:195], v[194:195], v[36:39]
    v_mfma_f32_4x4x4_16b_bf16 v[44:47], v[18:19], v[64:65], v[44:47]
    v_mfma_f32_4x4x4_16b_bf16 v[24:27], v[18:19], v[196:197], v[24:27]
    v_mfma_f32_4x4x4_16b_bf16 v[32:35], v[196:197], v[196:197], v[32:35]
    v_mfma_f32_4x4x4_16b_bf16 v[40:43], v[18:19], v[62:63], v[40:43]
    v_mfma_f32_4x4x4_16b_bf16 v[28:31], v[18:19], v[198:199], v[28:31]
    v_mfma_f32_4x4x4_16b_bf16 v[36:39], v[198:199], v[198:199], v[36:39]
    v_mfma_f32_4x4x4_16b_bf16 v[44:47], v[18:19], v[66:67], v[44:47]
    v_mfma_f32_4x4x4_16b_bf16 v[24:27], v[18:19], v[200:201], v[24:27]
    v_mfma_f32_4x4x4_16b_bf16 v[32:35], v[200:201], v[200:201], v[32:35]
    v_mfma_f32_4x4x4_16b_bf16 v[28:31], v[18:19], v[202:203], v[28:31]
    v_mfma_f32_4x4x4_16b_bf16 v[36:39], v[202:203], v[202:203], v[36:39]
    v_mfma_f32_4x4x4_16b_bf16 v[24:27], v[18:19], v[204:205], v[24:27]
    v_mfma_f32_4x4x4_16b_bf16 v[32:35], v[204:205], v[204:205], v[32:35]
    v_mfma_f32_4x4x4_16b_bf16 v[28:31], v[18:19], v[206:207], v[28:31]
    v_mfma_f32_4x4x4_16b_bf16 v[36:39], v[206:207], v[206:207], v[36:39]
    s_waitcnt lgkmcnt(5)
    v_mfma_f32_32x32x16_bf16 v[76:91], v[68:71], v[208:211], v[76:91]
    ds_read_b128 v[216:219], v14 offset:0
    ds_read_b64_tr_b16 v[60:61], v10 offset:0
    v_xor_b32 v7, 64, v10
    ds_read_b64_tr_b16 v[62:63], v10 offset:512
    v_mfma_f32_32x32x16_bf16 v[92:107], v[72:75], v[208:211], v[92:107]
    ds_read_b64_tr_b16 v[64:65], v7 offset:0
    ds_read_b64_tr_b16 v[66:67], v7 offset:512
    s_waitcnt lgkmcnt(5)
    v_mfma_f32_32x32x16_bf16 v[76:91], v[52:55], v[212:215], v[76:91]
    ds_read_b128 v[220:223], v15 offset:0
    ds_read_b64_tr_b16 v[68:69], v11 offset:0
    v_xor_b32 v7, 64, v11
    ds_read_b64_tr_b16 v[70:71], v11 offset:512
    v_mfma_f32_32x32x16_bf16 v[92:107], v[56:59], v[212:215], v[92:107]
    ds_read_b64_tr_b16 v[72:73], v7 offset:0
    ds_read_b64_tr_b16 v[74:75], v7 offset:512
    s_barrier
    s_waitcnt lgkmcnt(5)
    v_mfma_f32_32x32x16_bf16 v[76:91], v[60:63], v[216:219], v[76:91]
    ds_read_b128 v[224:227], v12 offset:24576
    ds_read_b64_tr_b16 v[52:53], v8 offset:24576
    v_xor_b32 v7, 64, v8
    ds_read_b64_tr_b16 v[54:55], v8 offset:25088
    v_mfma_f32_32x32x16_bf16 v[92:107], v[64:67], v[216:219], v[92:107]
    ds_read_b64_tr_b16 v[56:57], v7 offset:24576
    ds_read_b64_tr_b16 v[58:59], v7 offset:25088
    s_waitcnt lgkmcnt(5)
    v_mfma_f32_32x32x16_bf16 v[76:91], v[68:71], v[220:223], v[76:91]
    ds_read_b128 v[228:231], v13 offset:24576
    ds_read_b64_tr_b16 v[60:61], v9 offset:24576
    v_xor_b32 v7, 64, v9
    ds_read_b64_tr_b16 v[62:63], v9 offset:25088
    v_mfma_f32_32x32x16_bf16 v[92:107], v[72:75], v[220:223], v[92:107]
    ds_read_b64_tr_b16 v[64:65], v7 offset:24576
    ds_read_b64_tr_b16 v[66:67], v7 offset:25088
    v_mfma_f32_4x4x4_16b_bf16 v[24:27], v[18:19], v[208:209], v[24:27]
    v_mfma_f32_4x4x4_16b_bf16 v[32:35], v[208:209], v[208:209], v[32:35]
    v_mfma_f32_4x4x4_16b_bf16 v[40:43], v[18:19], v[68:69], v[40:43]
    v_mfma_f32_4x4x4_16b_bf16 v[28:31], v[18:19], v[210:211], v[28:31]
    v_mfma_f32_4x4x4_16b_bf16 v[36:39], v[210:211], v[210:211], v[36:39]
    v_mfma_f32_4x4x4_16b_bf16 v[44:47], v[18:19], v[72:73], v[44:47]
    v_mfma_f32_4x4x4_16b_bf16 v[24:27], v[18:19], v[212:213], v[24:27]
    v_mfma_f32_4x4x4_16b_bf16 v[32:35], v[212:213], v[212:213], v[32:35]
    v_mfma_f32_4x4x4_16b_bf16 v[40:43], v[18:19], v[70:71], v[40:43]
    v_mfma_f32_4x4x4_16b_bf16 v[28:31], v[18:19], v[214:215], v[28:31]
    v_mfma_f32_4x4x4_16b_bf16 v[36:39], v[214:215], v[214:215], v[36:39]
    v_mfma_f32_4x4x4_16b_bf16 v[44:47], v[18:19], v[74:75], v[44:47]
    v_mfma_f32_4x4x4_16b_bf16 v[24:27], v[18:19], v[216:217], v[24:27]
    v_mfma_f32_4x4x4_16b_bf16 v[32:35], v[216:217], v[216:217], v[32:35]
    v_mfma_f32_4x4x4_16b_bf16 v[28:31], v[18:19], v[218:219], v[28:31]
    v_mfma_f32_4x4x4_16b_bf16 v[36:39], v[218:219], v[218:219], v[36:39]
    v_mfma_f32_4x4x4_16b_bf16 v[24:27], v[18:19], v[220:221], v[24:27]
    v_mfma_f32_4x4x4_16b_bf16 v[32:35], v[220:221], v[220:221], v[32:35]
    v_mfma_f32_4x4x4_16b_bf16 v[28:31], v[18:19], v[222:223], v[28:31]
    v_mfma_f32_4x4x4_16b_bf16 v[36:39], v[222:223], v[222:223], v[36:39]
    s_waitcnt lgkmcnt(5)
    v_mfma_f32_32x32x16_bf16 v[76:91], v[52:55], v[224:227], v[76:91]
    ds_read_b128 v[232:235], v14 offset:24576
    ds_read_b64_tr_b16 v[68:69], v10 offset:24576
    v_xor_b32 v7, 64, v10
    ds_read_b64_tr_b16 v[70:71], v10 offset:25088
    v_mfma_f32_32x32x16_bf16 v[92:107], v[56:59], v[224:227], v[92:107]
    ds_read_b64_tr_b16 v[72:73], v7 offset:24576
    ds_read_b64_tr_b16 v[74:75], v7 offset:25088
    s_waitcnt lgkmcnt(5)
    v_mfma_f32_32x32x16_bf16 v[76:91], v[60:63], v[228:231], v[76:91]
    ds_read_b128 v[236:239], v15 offset:24576
    ds_read_b64_tr_b16 v[52:53], v11 offset:24576
    v_xor_b32 v7, 64, v11
    ds_read_b64_tr_b16 v[54:55], v11 offset:25088
    v_mfma_f32_32x32x16_bf16 v[92:107], v[64:67], v[228:231], v[92:107]
    ds_read_b64_tr_b16 v[56:57], v7 offset:24576
    ds_read_b64_tr_b16 v[58:59], v7 offset:25088
    s_barrier
    v_add_u32 v8, 0xc000, v8
    v_add_u32 v9, 0xc000, v9
    v_add_u32 v10, 0xc000, v10
    v_add_u32 v11, 0xc000, v11
    v_add_u32 v12, 0xc000, v12
    v_add_u32 v13, 0xc000, v13
    v_add_u32 v14, 0xc000, v14
    v_add_u32 v15, 0xc000, v15
    s_waitcnt lgkmcnt(5)
    v_mfma_f32_32x32x16_bf16 v[76:91], v[68:71], v[232:235], v[76:91]
    ds_read_b128 v[240:243], v12 offset:0
    ds_read_b64_tr_b16 v[60:61], v8 offset:0
    v_xor_b32 v7, 64, v8
    ds_read_b64_tr_b16 v[62:63], v8 offset:512
    v_mfma_f32_32x32x16_bf16 v[92:107], v[72:75], v[232:235], v[92:107]
    ds_read_b64_tr_b16 v[64:65], v7 offset:0
    ds_read_b64_tr_b16 v[66:67], v7 offset:512
    s_waitcnt lgkmcnt(5)
    v_mfma_f32_32x32x16_bf16 v[76:91], v[52:55], v[236:239], v[76:91]
    ds_read_b128 v[244:247], v13 offset:0
    ds_read_b64_tr_b16 v[68:69], v9 offset:0
    v_xor_b32 v7, 64, v9
    ds_read_b64_tr_b16 v[70:71], v9 offset:512
    v_mfma_f32_32x32x16_bf16 v[92:107], v[56:59], v[236:239], v[92:107]
    ds_read_b64_tr_b16 v[72:73], v7 offset:0
    ds_read_b64_tr_b16 v[74:75], v7 offset:512
    v_mfma_f32_4x4x4_16b_bf16 v[24:27], v[18:19], v[224:225], v[24:27]
    v_mfma_f32_4x4x4_16b_bf16 v[32:35], v[224:225], v[224:225], v[32:35]
    v_mfma_f32_4x4x4_16b_bf16 v[40:43], v[18:19], v[52:53], v[40:43]
    v_mfma_f32_4x4x4_16b_bf16 v[28:31], v[18:19], v[226:227], v[28:31]
    v_mfma_f32_4x4x4_16b_bf16 v[36:39], v[226:227], v[226:227], v[36:39]
    v_mfma_f32_4x4x4_16b_bf16 v[44:47], v[18:19], v[56:57], v[44:47]
    v_mfma_f32_4x4x4_16b_bf16 v[24:27], v[18:19], v[228:229], v[24:27]
    v_mfma_f32_4x4x4_16b_bf16 v[32:35], v[228:229], v[228:229], v[32:35]
    v_mfma_f32_4x4x4_16b_bf16 v[40:43], v[18:19], v[54:55], v[40:43]
    v_mfma_f32_4x4x4_16b_bf16 v[28:31], v[18:19], v[230:231], v[28:31]
    v_mfma_f32_4x4x4_16b_bf16 v[36:39], v[230:231], v[230:231], v[36:39]
    v_mfma_f32_4x4x4_16b_bf16 v[44:47], v[18:19], v[58:59], v[44:47]
    v_mfma_f32_4x4x4_16b_bf16 v[24:27], v[18:19], v[232:233], v[24:27]
    v_mfma_f32_4x4x4_16b_bf16 v[32:35], v[232:233], v[232:233], v[32:35]
    v_mfma_f32_4x4x4_16b_bf16 v[28:31], v[18:19], v[234:235], v[28:31]
    v_mfma_f32_4x4x4_16b_bf16 v[36:39], v[234:235], v[234:235], v[36:39]
    v_mfma_f32_4x4x4_16b_bf16 v[24:27], v[18:19], v[236:237], v[24:27]
    v_mfma_f32_4x4x4_16b_bf16 v[32:35], v[236:237], v[236:237], v[32:35]
    v_mfma_f32_4x4x4_16b_bf16 v[28:31], v[18:19], v[238:239], v[28:31]
    v_mfma_f32_4x4x4_16b_bf16 v[36:39], v[238:239], v[238:239], v[36:39]
    s_waitcnt lgkmcnt(5)
    v_mfma_f32_32x32x16_bf16 v[76:91], v[60:63], v[240:243], v[76:91]
    ds_read_b128 v[248:251], v14 offset:0
    ds_read_b64_tr_b16 v[52:53], v10 offset:0
    v_xor_b32 v7, 64, v10
    ds_read_b64_tr_b16 v[54:55], v10 offset:512
    v_mfma_f32_32x32x16_bf16 v[92:107], v[64:67], v[240:243], v[92:107]
    ds_read_b64_tr_b16 v[56:57], v7 offset:0
    ds_read_b64_tr_b16 v[58:59], v7 offset:512
    s_waitcnt lgkmcnt(5)
    v_mfma_f32_32x32x16_bf16 v[76:91], v[68:71], v[244:247], v[76:91]
    ds_read_b128 v[252:255], v15 offset:0
    ds_read_b64_tr_b16 v[60:61], v11 offset:0
    v_xor_b32 v7, 64, v11
    ds_read_b64_tr_b16 v[62:63], v11 offset:512
    v_mfma_f32_32x32x16_bf16 v[92:107], v[72:75], v[244:247], v[92:107]
    ds_read_b64_tr_b16 v[64:65], v7 offset:0
    ds_read_b64_tr_b16 v[66:67], v7 offset:512
    s_waitcnt lgkmcnt(5)
    v_mfma_f32_32x32x16_bf16 v[76:91], v[52:55], v[248:251], v[76:91]
    v_mfma_f32_32x32x16_bf16 v[92:107], v[56:59], v[248:251], v[92:107]
    s_waitcnt lgkmcnt(0)
    v_mfma_f32_32x32x16_bf16 v[76:91], v[60:63], v[252:255], v[76:91]
    v_mfma_f32_32x32x16_bf16 v[92:107], v[64:67], v[252:255], v[92:107]
    v_mfma_f32_4x4x4_16b_bf16 v[24:27], v[18:19], v[240:241], v[24:27]
    v_mfma_f32_4x4x4_16b_bf16 v[32:35], v[240:241], v[240:241], v[32:35]
    v_mfma_f32_4x4x4_16b_bf16 v[40:43], v[18:19], v[60:61], v[40:43]
    v_mfma_f32_4x4x4_16b_bf16 v[28:31], v[18:19], v[242:243], v[28:31]
    v_mfma_f32_4x4x4_16b_bf16 v[36:39], v[242:243], v[242:243], v[36:39]
    v_mfma_f32_4x4x4_16b_bf16 v[44:47], v[18:19], v[64:65], v[44:47]
    v_mfma_f32_4x4x4_16b_bf16 v[24:27], v[18:19], v[244:245], v[24:27]
    v_mfma_f32_4x4x4_16b_bf16 v[32:35], v[244:245], v[244:245], v[32:35]
    v_mfma_f32_4x4x4_16b_bf16 v[40:43], v[18:19], v[62:63], v[40:43]
    v_mfma_f32_4x4x4_16b_bf16 v[28:31], v[18:19], v[246:247], v[28:31]
    v_mfma_f32_4x4x4_16b_bf16 v[36:39], v[246:247], v[246:247], v[36:39]
    v_mfma_f32_4x4x4_16b_bf16 v[44:47], v[18:19], v[66:67], v[44:47]
    v_mfma_f32_4x4x4_16b_bf16 v[24:27], v[18:19], v[248:249], v[24:27]
    v_mfma_f32_4x4x4_16b_bf16 v[32:35], v[248:249], v[248:249], v[32:35]
    v_mfma_f32_4x4x4_16b_bf16 v[28:31], v[18:19], v[250:251], v[28:31]
    v_mfma_f32_4x4x4_16b_bf16 v[36:39], v[250:251], v[250:251], v[36:39]
    v_mfma_f32_4x4x4_16b_bf16 v[24:27], v[18:19], v[252:253], v[24:27]
    v_mfma_f32_4x4x4_16b_bf16 v[32:35], v[252:253], v[252:253], v[32:35]
    v_mfma_f32_4x4x4_16b_bf16 v[28:31], v[18:19], v[254:255], v[28:31]
    v_mfma_f32_4x4x4_16b_bf16 v[36:39], v[254:255], v[254:255], v[36:39]
    v_permlane32_swap_b32 v40, v44
    s_nop 3
    v_add_f32 v40, v40, v44
    v_add_f32 v24, v24, v28
    ds_write_b32 v121, v40 offset:24576
    v_pk_add_f32 v[32:33], v[32:33], v[36:37]
    v_pk_add_f32 v[34:35], v[34:35], v[38:39]
    v_cndmask_b32 v32, v32, v33, s[50:51]
    v_cndmask_b32 v32, v32, v34, s[52:53]
    v_cndmask_b32 v32, v32, v35, s[54:55]
    s_waitcnt lgkmcnt(0)
    s_barrier
    ds_read_b128 v[4:7], v127 offset:24576
    v_permlane32_swap_b32 v24, v32
    v_mov_b64 v[8:9], 0
    v_add_f32 v24, v24, v32
    v_mov_b32 v32, v24
    v_mov_b64 v[10:11], 0
    v_mov_b64 v[12:13], 0
    v_permlane32_swap_b32 v24, v32
    v_mov_b64 v[14:15], 0
    v_mul_f32 v24, 0x3b000000, v24
    v_mul_f32 v32, 0x3b000000, v32
    v_fma_f32 v32, -v24, v24, v32
    v_max_f32 v32, 0, v32
    v_cvt_pk_bf16_f32 v16, v24, v32
    v_lshlrev_b32 v24, 16, v16
    v_and_b32 v16, 0xffff0000, v16
    v_add_f32 v16, 0x3727c5ac, v16
    v_cvt_pk_bf16_f32 v16, v16, v16
    v_and_b32 v16, 0xffff0000, v16
    v_sqrt_f32 v16, v16
    s_nop 0
    v_cvt_pk_bf16_f32 v16, v16, v16
    v_and_b32 v16, 0xffff0000, v16
    v_rcp_f32 v16, v16
    s_waitcnt lgkmcnt(0)
    v_pk_add_f32 v[4:5], v[4:5], v[6:7]
    v_mul_f32 v17, v24, v16
    v_add_f32 v4, v4, v5
    v_sub_f32 v17, 0, v17
    ds_write_b32 v119, v4 offset:26112
    v_pk_mul_f32 v[92:93], v[92:93], v[16:17] op_sel_hi:[1,0]
    v_pk_mul_f32 v[94:95], v[94:95], v[16:17] op_sel_hi:[1,0]
    v_pk_mul_f32 v[96:97], v[96:97], v[16:17] op_sel_hi:[1,0]
    v_pk_mul_f32 v[98:99], v[98:99], v[16:17] op_sel_hi:[1,0]
    v_pk_mul_f32 v[100:101], v[100:101], v[16:17] op_sel_hi:[1,0]
    v_pk_mul_f32 v[102:103], v[102:103], v[16:17] op_sel_hi:[1,0]
    v_pk_mul_f32 v[104:105], v[104:105], v[16:17] op_sel_hi:[1,0]
    v_pk_mul_f32 v[106:107], v[106:107], v[16:17] op_sel_hi:[1,0]
    s_waitcnt lgkmcnt(0)
    ds_read_b128 v[40:43], v118 offset:26240
    ds_read_b128 v[44:47], v118 offset:26272
    ds_read_b128 v[48:51], v118 offset:26304
    ds_read_b128 v[52:55], v118 offset:26336
    ds_read_b128 v[24:27], v118 offset:26112
    ds_read_b128 v[28:31], v118 offset:26144
    ds_read_b128 v[32:35], v118 offset:26176
    ds_read_b128 v[36:39], v118 offset:26208
    v_pk_mul_f32 v[76:77], v[76:77], v[16:17] op_sel_hi:[1,0]
    v_pk_mul_f32 v[78:79], v[78:79], v[16:17] op_sel_hi:[1,0]
    v_pk_mul_f32 v[80:81], v[80:81], v[16:17] op_sel_hi:[1,0]
    v_pk_mul_f32 v[82:83], v[82:83], v[16:17] op_sel_hi:[1,0]
    v_pk_mul_f32 v[84:85], v[84:85], v[16:17] op_sel_hi:[1,0]
    v_pk_mul_f32 v[86:87], v[86:87], v[16:17] op_sel_hi:[1,0]
    v_pk_mul_f32 v[88:89], v[88:89], v[16:17] op_sel_hi:[1,0]
    v_pk_mul_f32 v[90:91], v[90:91], v[16:17] op_sel_hi:[1,0]
    s_cmp_ge_u32 s57, 8
    s_cbranch_scc1 L_vt
    s_waitcnt lgkmcnt(4)
    v_pk_fma_f32 v[92:93], v[40:41], v[16:17], v[92:93] op_sel:[0,1,0] op_sel_hi:[1,1,1]
    v_pk_fma_f32 v[94:95], v[42:43], v[16:17], v[94:95] op_sel:[0,1,0] op_sel_hi:[1,1,1]
    v_pk_fma_f32 v[96:97], v[44:45], v[16:17], v[96:97] op_sel:[0,1,0] op_sel_hi:[1,1,1]
    v_pk_fma_f32 v[98:99], v[46:47], v[16:17], v[98:99] op_sel:[0,1,0] op_sel_hi:[1,1,1]
    v_pk_fma_f32 v[100:101], v[48:49], v[16:17], v[100:101] op_sel:[0,1,0] op_sel_hi:[1,1,1]
    v_pk_fma_f32 v[102:103], v[50:51], v[16:17], v[102:103] op_sel:[0,1,0] op_sel_hi:[1,1,1]
    v_pk_fma_f32 v[104:105], v[52:53], v[16:17], v[104:105] op_sel:[0,1,0] op_sel_hi:[1,1,1]
    v_pk_fma_f32 v[106:107], v[54:55], v[16:17], v[106:107] op_sel:[0,1,0] op_sel_hi:[1,1,1]
    v_cvt_pk_bf16_f32 v64, v92, v93
    v_cvt_pk_bf16_f32 v65, v94, v95
    v_cvt_pk_bf16_f32 v66, v96, v97
    v_cvt_pk_bf16_f32 v67, v98, v99
    v_cvt_pk_bf16_f32 v68, v100, v101
    v_cvt_pk_bf16_f32 v69, v102, v103
    v_cvt_pk_bf16_f32 v70, v104, v105
    v_cvt_pk_bf16_f32 v71, v106, v107
    buffer_store_dwordx4 v[64:67], v120, s[24:27], s48 offen sc1
    buffer_store_dwordx4 v[68:71], v120, s[24:27], s62 offen sc1
    s_waitcnt lgkmcnt(0)
    v_pk_fma_f32 v[76:77], v[24:25], v[16:17], v[76:77] op_sel:[0,1,0] op_sel_hi:[1,1,1]
    v_pk_fma_f32 v[78:79], v[26:27], v[16:17], v[78:79] op_sel:[0,1,0] op_sel_hi:[1,1,1]
    v_pk_fma_f32 v[80:81], v[28:29], v[16:17], v[80:81] op_sel:[0,1,0] op_sel_hi:[1,1,1]
    v_pk_fma_f32 v[82:83], v[30:31], v[16:17], v[82:83] op_sel:[0,1,0] op_sel_hi:[1,1,1]
    v_pk_fma_f32 v[84:85], v[32:33], v[16:17], v[84:85] op_sel:[0,1,0] op_sel_hi:[1,1,1]
    v_pk_fma_f32 v[86:87], v[34:35], v[16:17], v[86:87] op_sel:[0,1,0] op_sel_hi:[1,1,1]
    v_pk_fma_f32 v[88:89], v[36:37], v[16:17], v[88:89] op_sel:[0,1,0] op_sel_hi:[1,1,1]
    v_pk_fma_f32 v[90:91], v[38:39], v[16:17], v[90:91] op_sel:[0,1,0] op_sel_hi:[1,1,1]
    v_cvt_pk_bf16_f32 v56, v76, v77
    v_cvt_pk_bf16_f32 v57, v78, v79
    v_cvt_pk_bf16_f32 v58, v80, v81
    v_cvt_pk_bf16_f32 v59, v82, v83
    v_cvt_pk_bf16_f32 v60, v84, v85
    v_cvt_pk_bf16_f32 v61, v86, v87
    v_cvt_pk_bf16_f32 v62, v88, v89
    v_cvt_pk_bf16_f32 v63, v90, v91
    buffer_store_dwordx4 v[56:59], v120, s[24:27], s46 offen sc1
    buffer_store_dwordx4 v[60:63], v120, s[24:27], s47 offen sc1
    v_pk_fma_f32 v[8:9], v[76:77], v[76:77], v[8:9]
    v_pk_fma_f32 v[10:11], v[84:85], v[84:85], v[10:11]
    v_pk_fma_f32 v[8:9], v[78:79], v[78:79], v[8:9]
    v_pk_fma_f32 v[10:11], v[86:87], v[86:87], v[10:11]
    v_pk_fma_f32 v[8:9], v[80:81], v[80:81], v[8:9]
    v_pk_fma_f32 v[10:11], v[88:89], v[88:89], v[10:11]
    v_pk_fma_f32 v[8:9], v[82:83], v[82:83], v[8:9]
    v_pk_fma_f32 v[10:11], v[90:91], v[90:91], v[10:11]
    s_branch L_q
L_vt:
    s_waitcnt lgkmcnt(4)
    v_pk_fma_f32 v[92:93], v[40:41], v[16:17], v[92:93] op_sel:[0,1,0] op_sel_hi:[1,1,1]
    v_pk_fma_f32 v[94:95], v[42:43], v[16:17], v[94:95] op_sel:[0,1,0] op_sel_hi:[1,1,1]
    v_pk_fma_f32 v[96:97], v[44:45], v[16:17], v[96:97] op_sel:[0,1,0] op_sel_hi:[1,1,1]
    v_pk_fma_f32 v[98:99], v[46:47], v[16:17], v[98:99] op_sel:[0,1,0] op_sel_hi:[1,1,1]
    v_pk_fma_f32 v[100:101], v[48:49], v[16:17], v[100:101] op_sel:[0,1,0] op_sel_hi:[1,1,1]
    v_pk_fma_f32 v[102:103], v[50:51], v[16:17], v[102:103] op_sel:[0,1,0] op_sel_hi:[1,1,1]
    v_pk_fma_f32 v[104:105], v[52:53], v[16:17], v[104:105] op_sel:[0,1,0] op_sel_hi:[1,1,1]
    v_pk_fma_f32 v[106:107], v[54:55], v[16:17], v[106:107] op_sel:[0,1,0] op_sel_hi:[1,1,1]
    v_cvt_pk_bf16_f32 v64, v92, v93
    v_cvt_pk_bf16_f32 v65, v94, v95
    v_cvt_pk_bf16_f32 v66, v96, v97
    v_cvt_pk_bf16_f32 v67, v98, v99
    v_cvt_pk_bf16_f32 v68, v100, v101
    v_cvt_pk_bf16_f32 v69, v102, v103
    v_cvt_pk_bf16_f32 v70, v104, v105
    v_cvt_pk_bf16_f32 v71, v106, v107
    ds_write_b64 v124, v[64:65] offset:2304
    ds_write_b64 v124, v[66:67] offset:2320
    ds_write_b64 v124, v[68:69] offset:2336
    ds_write_b64 v124, v[70:71] offset:2352
    s_waitcnt lgkmcnt(4)
    v_pk_fma_f32 v[76:77], v[24:25], v[16:17], v[76:77] op_sel:[0,1,0] op_sel_hi:[1,1,1]
    v_pk_fma_f32 v[78:79], v[26:27], v[16:17], v[78:79] op_sel:[0,1,0] op_sel_hi:[1,1,1]
    v_pk_fma_f32 v[80:81], v[28:29], v[16:17], v[80:81] op_sel:[0,1,0] op_sel_hi:[1,1,1]
    v_pk_fma_f32 v[82:83], v[30:31], v[16:17], v[82:83] op_sel:[0,1,0] op_sel_hi:[1,1,1]
    v_pk_fma_f32 v[84:85], v[32:33], v[16:17], v[84:85] op_sel:[0,1,0] op_sel_hi:[1,1,1]
    v_pk_fma_f32 v[86:87], v[34:35], v[16:17], v[86:87] op_sel:[0,1,0] op_sel_hi:[1,1,1]
    v_pk_fma_f32 v[88:89], v[36:37], v[16:17], v[88:89] op_sel:[0,1,0] op_sel_hi:[1,1,1]
    v_pk_fma_f32 v[90:91], v[38:39], v[16:17], v[90:91] op_sel:[0,1,0] op_sel_hi:[1,1,1]
    ds_read_b64_tr_b16 v[40:41], v125 offset:2304
    ds_read_b64_tr_b16 v[42:43], v125 offset:2592
    ds_read_b64_tr_b16 v[44:45], v125 offset:3456
    ds_read_b64_tr_b16 v[46:47], v125 offset:3744
    v_cvt_pk_bf16_f32 v56, v76, v77
    v_cvt_pk_bf16_f32 v57, v78, v79
    v_cvt_pk_bf16_f32 v58, v80, v81
    v_cvt_pk_bf16_f32 v59, v82, v83
    v_cvt_pk_bf16_f32 v60, v84, v85
    v_cvt_pk_bf16_f32 v61, v86, v87
    v_cvt_pk_bf16_f32 v62, v88, v89
    v_cvt_pk_bf16_f32 v63, v90, v91
    ds_write_b64 v124, v[56:57] offset:0
    ds_write_b64 v124, v[58:59] offset:16
    ds_write_b64 v124, v[60:61] offset:32
    ds_write_b64 v124, v[62:63] offset:48
    ds_read_b64_tr_b16 v[48:49], v125 offset:0
    ds_read_b64_tr_b16 v[50:51], v125 offset:288
    ds_read_b64_tr_b16 v[52:53], v125 offset:1152
    ds_read_b64_tr_b16 v[54:55], v125 offset:1440
    s_waitcnt lgkmcnt(8)
    buffer_store_dwordx4 v[40:43], v126, s[24:27], s48 offen sc1
    buffer_store_dwordx4 v[44:47], v126, s[24:27], s48 offen offset:512 sc1
    v_pk_fma_f32 v[8:9], v[76:77], v[76:77], v[8:9]
    v_pk_fma_f32 v[10:11], v[84:85], v[84:85], v[10:11]
    v_pk_fma_f32 v[8:9], v[78:79], v[78:79], v[8:9]
    v_pk_fma_f32 v[10:11], v[86:87], v[86:87], v[10:11]
    v_pk_fma_f32 v[8:9], v[80:81], v[80:81], v[8:9]
    v_pk_fma_f32 v[10:11], v[88:89], v[88:89], v[10:11]
    v_pk_fma_f32 v[8:9], v[82:83], v[82:83], v[8:9]
    v_pk_fma_f32 v[10:11], v[90:91], v[90:91], v[10:11]
    s_waitcnt lgkmcnt(0)
    buffer_store_dwordx4 v[48:51], v126, s[24:27], s46 offen sc1
    buffer_store_dwordx4 v[52:55], v126, s[24:27], s46 offen offset:512 sc1
L_q:
    ds_read_b64_tr_b16 v[24:25], v108 offset:0
    ds_read_b64_tr_b16 v[26:27], v108 offset:256
    ds_read_b64_tr_b16 v[28:29], v109 offset:0
    ds_read_b64_tr_b16 v[30:31], v109 offset:256
    ds_read_b64_tr_b16 v[32:33], v110 offset:0
    ds_read_b64_tr_b16 v[34:35], v110 offset:256
    ds_read_b64_tr_b16 v[36:37], v111 offset:0
    ds_read_b64_tr_b16 v[38:39], v111 offset:256
    s_waitcnt lgkmcnt(6)
    v_mfma_f32_32x32x16_bf16 v[76:91], v[24:27], v[128:131], 0
    v_pk_fma_f32 v[12:13], v[92:93], v[92:93], v[12:13]
    v_pk_fma_f32 v[14:15], v[100:101], v[100:101], v[14:15]
    v_pk_fma_f32 v[12:13], v[94:95], v[94:95], v[12:13]
    ds_read_b64_tr_b16 v[24:25], v108 offset:4096
    ds_read_b64_tr_b16 v[26:27], v108 offset:4352
    s_waitcnt lgkmcnt(6)
    v_mfma_f32_32x32x16_bf16 v[76:91], v[28:31], v[132:135], v[76:91]
    v_pk_fma_f32 v[14:15], v[102:103], v[102:103], v[14:15]
    v_pk_fma_f32 v[12:13], v[96:97], v[96:97], v[12:13]
    v_pk_fma_f32 v[14:15], v[104:105], v[104:105], v[14:15]
    ds_read_b64_tr_b16 v[28:29], v109 offset:4096
    ds_read_b64_tr_b16 v[30:31], v109 offset:4352
    s_waitcnt lgkmcnt(6)
    v_mfma_f32_32x32x16_bf16 v[76:91], v[32:35], v[136:139], v[76:91]
    v_pk_fma_f32 v[12:13], v[98:99], v[98:99], v[12:13]
    v_pk_fma_f32 v[14:15], v[106:107], v[106:107], v[14:15]
    v_add_f32 v8, v8, v9
    ds_read_b64_tr_b16 v[32:33], v110 offset:4096
    ds_read_b64_tr_b16 v[34:35], v110 offset:4352
    s_waitcnt lgkmcnt(6)
    v_mfma_f32_32x32x16_bf16 v[76:91], v[36:39], v[140:143], v[76:91]
    v_add_f32 v10, v10, v11
    v_add_f32 v12, v12, v13
    v_add_f32 v14, v14, v15
    ds_read_b64_tr_b16 v[36:37], v111 offset:4096
    ds_read_b64_tr_b16 v[38:39], v111 offset:4352
    s_waitcnt lgkmcnt(6)
    v_mfma_f32_32x32x16_bf16 v[76:91], v[24:27], v[144:147], v[76:91]
    s_nop 0
    s_nop 0
    v_permlane32_swap_b32 v8, v10
    ds_read_b64_tr_b16 v[24:25], v108 offset:8192
    ds_read_b64_tr_b16 v[26:27], v108 offset:8448
    s_waitcnt lgkmcnt(6)
    v_mfma_f32_32x32x16_bf16 v[76:91], v[28:31], v[148:151], v[76:91]
    v_permlane32_swap_b32 v12, v14
    s_nop 0
    v_add_f32 v8, v8, v10
    ds_read_b64_tr_b16 v[28:29], v109 offset:8192
    ds_read_b64_tr_b16 v[30:31], v109 offset:8448
    s_waitcnt lgkmcnt(6)
    v_mfma_f32_32x32x16_bf16 v[76:91], v[32:35], v[152:155], v[76:91]
    v_add_f32 v12, v12, v14
    s_nop 0
    v_max_u32_dpp v8, v8, v8 row_shr:1 row_mask:0xf bank_mask:0xf
    ds_read_b64_tr_b16 v[32:33], v110 offset:8192
    ds_read_b64_tr_b16 v[34:35], v110 offset:8448
    s_waitcnt lgkmcnt(6)
    v_mfma_f32_32x32x16_bf16 v[76:91], v[36:39], v[156:159], v[76:91]
    v_max_u32_dpp v12, v12, v12 row_shr:1 row_mask:0xf bank_mask:0xf
    s_nop 0
    v_max_u32_dpp v8, v8, v8 row_shr:2 row_mask:0xf bank_mask:0xf
    ds_read_b64_tr_b16 v[36:37], v111 offset:8192
    ds_read_b64_tr_b16 v[38:39], v111 offset:8448
    s_waitcnt lgkmcnt(6)
    v_mfma_f32_32x32x16_bf16 v[76:91], v[24:27], v[160:163], v[76:91]
    v_max_u32_dpp v12, v12, v12 row_shr:2 row_mask:0xf bank_mask:0xf
    s_nop 0
    v_max_u32_dpp v8, v8, v8 row_shr:4 row_mask:0xf bank_mask:0xf
    ds_read_b64_tr_b16 v[24:25], v108 offset:12288
    ds_read_b64_tr_b16 v[26:27], v108 offset:12544
    s_waitcnt lgkmcnt(6)
    v_mfma_f32_32x32x16_bf16 v[76:91], v[28:31], v[164:167], v[76:91]
    v_max_u32_dpp v12, v12, v12 row_shr:4 row_mask:0xf bank_mask:0xf
    s_nop 0
    v_max_u32_dpp v8, v8, v8 row_shr:8 row_mask:0xf bank_mask:0xf
    ds_read_b64_tr_b16 v[28:29], v109 offset:12288
    ds_read_b64_tr_b16 v[30:31], v109 offset:12544
    s_waitcnt lgkmcnt(6)
    v_mfma_f32_32x32x16_bf16 v[76:91], v[32:35], v[168:171], v[76:91]
    v_max_u32_dpp v12, v12, v12 row_shr:8 row_mask:0xf bank_mask:0xf
    s_nop 0
    v_max_u32_dpp v8, v8, v8 row_bcast:15 row_mask:0xa bank_mask:0xf
    ds_read_b64_tr_b16 v[32:33], v110 offset:12288
    ds_read_b64_tr_b16 v[34:35], v110 offset:12544
    s_waitcnt lgkmcnt(6)
    v_mfma_f32_32x32x16_bf16 v[76:91], v[36:39], v[172:175], v[76:91]
    v_max_u32_dpp v12, v12, v12 row_bcast:15 row_mask:0xa bank_mask:0xf
    s_nop 0
    v_max_u32_dpp v8, v8, v8 row_bcast:31 row_mask:0xc bank_mask:0xf
    ds_read_b64_tr_b16 v[36:37], v111 offset:12288
    ds_read_b64_tr_b16 v[38:39], v111 offset:12544
    s_waitcnt lgkmcnt(6)
    v_mfma_f32_32x32x16_bf16 v[76:91], v[24:27], v[176:179], v[76:91]
    v_max_u32_dpp v12, v12, v12 row_bcast:31 row_mask:0xc bank_mask:0xf
    s_nop 0
    ds_read_b64_tr_b16 v[24:25], v108 offset:16384
    ds_read_b64_tr_b16 v[26:27], v108 offset:16640
    s_waitcnt lgkmcnt(6)
    v_mfma_f32_32x32x16_bf16 v[76:91], v[28:31], v[180:183], v[76:91]
    ds_read_b64_tr_b16 v[28:29], v109 offset:16384
    ds_read_b64_tr_b16 v[30:31], v109 offset:16640
    s_waitcnt lgkmcnt(6)
    v_mfma_f32_32x32x16_bf16 v[76:91], v[32:35], v[184:187], v[76:91]
    ds_read_b64_tr_b16 v[32:33], v110 offset:16384
    ds_read_b64_tr_b16 v[34:35], v110 offset:16640
    s_waitcnt lgkmcnt(6)
    v_mfma_f32_32x32x16_bf16 v[76:91], v[36:39], v[188:191], v[76:91]
    ds_read_b64_tr_b16 v[36:37], v111 offset:16384
    ds_read_b64_tr_b16 v[38:39], v111 offset:16640
    s_waitcnt lgkmcnt(6)
    v_mfma_f32_32x32x16_bf16 v[76:91], v[24:27], v[192:195], v[76:91]
    ds_read_b64_tr_b16 v[24:25], v108 offset:20480
    ds_read_b64_tr_b16 v[26:27], v108 offset:20736
    s_waitcnt lgkmcnt(6)
    v_mfma_f32_32x32x16_bf16 v[76:91], v[28:31], v[196:199], v[76:91]
    ds_read_b64_tr_b16 v[28:29], v109 offset:20480
    ds_read_b64_tr_b16 v[30:31], v109 offset:20736
    s_waitcnt lgkmcnt(6)
    v_mfma_f32_32x32x16_bf16 v[76:91], v[32:35], v[200:203], v[76:91]
    s_mov_b64 exec, s[60:61]
    ds_write_b32 v122, v8 offset:28160
    ds_write_b32 v122, v12 offset:28176
    s_mov_b64 exec, -1
    ds_read_b64_tr_b16 v[32:33], v110 offset:20480
    ds_read_b64_tr_b16 v[34:35], v110 offset:20736
    s_waitcnt lgkmcnt(6)
    v_mfma_f32_32x32x16_bf16 v[76:91], v[36:39], v[204:207], v[76:91]
    ds_read_b64_tr_b16 v[36:37], v111 offset:20480
    ds_read_b64_tr_b16 v[38:39], v111 offset:20736
    s_waitcnt lgkmcnt(6)
    v_mfma_f32_32x32x16_bf16 v[76:91], v[24:27], v[208:211], v[76:91]
    s_waitcnt vmcnt(0) lgkmcnt(0)
    s_barrier
    ds_read_b128 v[4:7], v123 offset:25600
    ds_read_b64_tr_b16 v[24:25], v108 offset:24576
    ds_read_b64_tr_b16 v[26:27], v108 offset:24832
    s_waitcnt lgkmcnt(6)
    v_mfma_f32_32x32x16_bf16 v[76:91], v[28:31], v[212:215], v[76:91]
    ds_read_b64_tr_b16 v[28:29], v109 offset:24576
    ds_read_b64_tr_b16 v[30:31], v109 offset:24832
    s_waitcnt lgkmcnt(6)
    v_mfma_f32_32x32x16_bf16 v[76:91], v[32:35], v[216:219], v[76:91]
    ds_read_b64_tr_b16 v[32:33], v110 offset:24576
    ds_read_b64_tr_b16 v[34:35], v110 offset:24832
    s_waitcnt lgkmcnt(6)
    v_mfma_f32_32x32x16_bf16 v[76:91], v[36:39], v[220:223], v[76:91]
    v_pk_add_f32 v[4:5], v[4:5], v[6:7]
    v_mul_f32 v16, 0x3eb8aa3b, v16
    v_add_f32 v4, v4, v5
    v_mul_f32 v17, 0x3eb8aa3b, v17
    ds_write_b32 v119, v4 offset:26112
    v_mov_b64 v[8:9], 0
    v_mov_b64 v[10:11], 0
    ds_read_b64_tr_b16 v[36:37], v111 offset:24576
    ds_read_b64_tr_b16 v[38:39], v111 offset:24832
    s_waitcnt lgkmcnt(6)
    v_mfma_f32_32x32x16_bf16 v[76:91], v[24:27], v[224:227], v[76:91]
    ds_read_b64_tr_b16 v[24:25], v108 offset:28672
    ds_read_b64_tr_b16 v[26:27], v108 offset:28928
    s_waitcnt lgkmcnt(6)
    v_mfma_f32_32x32x16_bf16 v[76:91], v[28:31], v[228:231], v[76:91]
    ds_read_b64_tr_b16 v[28:29], v109 offset:28672
    ds_read_b64_tr_b16 v[30:31], v109 offset:28928
    s_waitcnt lgkmcnt(6)
    v_mfma_f32_32x32x16_bf16 v[76:91], v[32:35], v[232:235], v[76:91]
    ds_read_b64_tr_b16 v[32:33], v110 offset:28672
    ds_read_b64_tr_b16 v[34:35], v110 offset:28928
    s_waitcnt lgkmcnt(6)
    v_mfma_f32_32x32x16_bf16 v[76:91], v[36:39], v[236:239], v[76:91]
    ds_read_b64_tr_b16 v[36:37], v111 offset:28672
    ds_read_b64_tr_b16 v[38:39], v111 offset:28928
    s_waitcnt lgkmcnt(6)
    v_mfma_f32_32x32x16_bf16 v[76:91], v[24:27], v[240:243], v[76:91]
    ds_read_b128 v[92:95], v118 offset:26112
    ds_read_b128 v[96:99], v118 offset:26144
    ds_read_b128 v[100:103], v118 offset:26176
    ds_read_b128 v[104:107], v118 offset:26208
    s_waitcnt lgkmcnt(4)
    v_mfma_f32_32x32x16_bf16 v[76:91], v[28:31], v[244:247], v[76:91]
    s_waitcnt lgkmcnt(2)
    v_mfma_f32_32x32x16_bf16 v[76:91], v[32:35], v[248:251], v[76:91]
    s_waitcnt lgkmcnt(0)
    v_mfma_f32_32x32x16_bf16 v[76:91], v[36:39], v[252:255], v[76:91]
    s_nop 11
    s_waitcnt lgkmcnt(0)
    v_pk_mul_f32 v[76:77], v[76:77], v[16:17] op_sel_hi:[1,0]
    v_pk_mul_f32 v[78:79], v[78:79], v[16:17] op_sel_hi:[1,0]
    v_pk_mul_f32 v[80:81], v[80:81], v[16:17] op_sel_hi:[1,0]
    v_pk_mul_f32 v[82:83], v[82:83], v[16:17] op_sel_hi:[1,0]
    v_pk_mul_f32 v[84:85], v[84:85], v[16:17] op_sel_hi:[1,0]
    v_pk_mul_f32 v[86:87], v[86:87], v[16:17] op_sel_hi:[1,0]
    v_pk_mul_f32 v[88:89], v[88:89], v[16:17] op_sel_hi:[1,0]
    v_pk_mul_f32 v[90:91], v[90:91], v[16:17] op_sel_hi:[1,0]
    v_pk_fma_f32 v[76:77], v[92:93], v[16:17], v[76:77] op_sel:[0,1,0] op_sel_hi:[1,1,1]
    v_pk_fma_f32 v[78:79], v[94:95], v[16:17], v[78:79] op_sel:[0,1,0] op_sel_hi:[1,1,1]
    v_pk_fma_f32 v[80:81], v[96:97], v[16:17], v[80:81] op_sel:[0,1,0] op_sel_hi:[1,1,1]
    v_pk_fma_f32 v[82:83], v[98:99], v[16:17], v[82:83] op_sel:[0,1,0] op_sel_hi:[1,1,1]
    v_pk_fma_f32 v[84:85], v[100:101], v[16:17], v[84:85] op_sel:[0,1,0] op_sel_hi:[1,1,1]
    v_pk_fma_f32 v[86:87], v[102:103], v[16:17], v[86:87] op_sel:[0,1,0] op_sel_hi:[1,1,1]
    v_pk_fma_f32 v[88:89], v[104:105], v[16:17], v[88:89] op_sel:[0,1,0] op_sel_hi:[1,1,1]
    v_pk_fma_f32 v[90:91], v[106:107], v[16:17], v[90:91] op_sel:[0,1,0] op_sel_hi:[1,1,1]
    v_cvt_pk_bf16_f32 v56, v76, v77
    v_cvt_pk_bf16_f32 v57, v78, v79
    v_cvt_pk_bf16_f32 v58, v80, v81
    v_cvt_pk_bf16_f32 v59, v82, v83
    v_cvt_pk_bf16_f32 v60, v84, v85
    v_cvt_pk_bf16_f32 v61, v86, v87
    v_cvt_pk_bf16_f32 v62, v88, v89
    v_cvt_pk_bf16_f32 v63, v90, v91
    ds_write_b128 v112, v[56:59] offset:40960
    ds_write_b128 v112, v[60:63] offset:45056
    v_pk_fma_f32 v[8:9], v[76:77], v[76:77], v[8:9]
    v_pk_fma_f32 v[10:11], v[84:85], v[84:85], v[10:11]
    v_pk_fma_f32 v[8:9], v[78:79], v[78:79], v[8:9]
    v_pk_fma_f32 v[10:11], v[86:87], v[86:87], v[10:11]
    v_pk_fma_f32 v[8:9], v[80:81], v[80:81], v[8:9]
    v_pk_fma_f32 v[10:11], v[88:89], v[88:89], v[10:11]
    v_pk_fma_f32 v[8:9], v[82:83], v[82:83], v[8:9]
    v_pk_fma_f32 v[10:11], v[90:91], v[90:91], v[10:11]
    v_add_f32 v8, v8, v9
    v_add_f32 v10, v10, v11
    s_nop 1
    v_permlane32_swap_b32 v8, v10
    s_nop 0
    v_add_f32 v8, v8, v10
    s_nop 1
    v_max_u32_dpp v8, v8, v8 row_shr:1 row_mask:0xf bank_mask:0xf
    s_nop 1
    v_max_u32_dpp v8, v8, v8 row_shr:2 row_mask:0xf bank_mask:0xf
    s_nop 1
    v_max_u32_dpp v8, v8, v8 row_shr:4 row_mask:0xf bank_mask:0xf
    s_nop 1
    v_max_u32_dpp v8, v8, v8 row_shr:8 row_mask:0xf bank_mask:0xf
    s_nop 1
    v_max_u32_dpp v8, v8, v8 row_bcast:15 row_mask:0xa bank_mask:0xf
    s_nop 1
    v_max_u32_dpp v8, v8, v8 row_bcast:31 row_mask:0xc bank_mask:0xf
    s_nop 1
    s_mov_b64 exec, s[60:61]
    ds_write_b32 v122, v8 offset:28192
    s_mov_b64 exec, -1
L_P2:
    s_load_dwordx2 s[4:5], s[0:1], 0
    s_load_dwordx2 s[6:7], s[0:1], 16
    s_load_dwordx4 s[8:11], s[0:1], 32
    s_load_dwordx4 s[12:15], s[0:1], 48
    s_load_dwordx2 s[16:17], s[0:1], 64
    s_setprio 3
    s_lshl_b32 s31, s29, 2
    s_lshr_b32 s33, s30, 3
    s_add_u32 s31, s31, s33
    s_and_b32 s32, s30, 7
    v_and_b32 v3, 31, v2
    v_lshrrev_b32 v6, 5, v2
    v_lshlrev_b32 v4, 5, v3
    v_lshl_add_u32 v4, v6, 4, v4
    v_and_b32 v5, 15, v2
    v_lshlrev_b32 v5, 4, v5
    v_lshl_add_u32 v5, v6, 8, v5
    v_lshlrev_b32 v7, 4, v2
    s_and_b32 s34, s28, 1
    s_lshr_b32 s35, s28, 1
    s_lshl_b32 s40, s57, 1
    s_add_u32 s40, s40, s34
    s_lshl_b32 s40, s40, 16
    s_lshl_b32 s33, s56, 12
    s_add_u32 s41, s40, s33
    s_lshl_b32 s33, s35, 14
    s_add_u32 s42, s40, s33
    s_add_u32 s43, s42, 0x400000
    s_add_u32 s42, s42, 0x200000
    s_lshl_b32 s45, s56, 10
    s_lshr_b32 s44, s57, 1
    s_lshl_b32 s44, s44, 11
    s_and_b32 s33, s57, 1
    s_lshl_b32 s33, s33, 4
    s_add_u32 s44, s44, s33
    s_add_u32 s44, s44, 0xac2000
    s_mov_b32 s46, 0x0000ffff
    s_mov_b32 s47, 0x0000ffff
    s_mov_b32 s23, 0x00020000
    v_and_b32 v8, 27, v2
    v_mov_b32 v9, 0x3f803f80
    v_cmp_eq_u32 vcc, 16, v8
    v_mov_b32 v208, 0xdddddddd
    s_nop 0
    v_cndmask_b32 v8, 0, v9, vcc
    v_cndmask_b32 v9, 0, v9, vcc
    v_mov_b64 v[176:177], v[8:9]
    v_mov_b64 v[178:179], v[8:9]
    v_mov_b64 v[180:181], v[8:9]
    v_mov_b64 v[182:183], v[8:9]
    v_mov_b64 v[184:185], v[8:9]
    v_mov_b64 v[186:187], v[8:9]
    v_mov_b64 v[188:189], v[8:9]
    v_mov_b64 v[190:191], v[8:9]
    v_mov_b64 v[192:193], v[8:9]
    v_mov_b64 v[194:195], v[8:9]
    v_mov_b64 v[196:197], v[8:9]
    v_mov_b64 v[198:199], v[8:9]
    v_mov_b64 v[200:201], v[8:9]
    v_mov_b64 v[202:203], v[8:9]
    v_mov_b64 v[204:205], v[8:9]
    v_mov_b64 v[206:207], v[8:9]
    v_mov_b64 v[80:81], 0
    v_mov_b64 v[82:83], 0
    v_mov_b64 v[84:85], 0
    v_mov_b64 v[86:87], 0
    v_mov_b64 v[88:89], 0
    v_mov_b64 v[90:91], 0
    v_mov_b64 v[92:93], 0
    v_mov_b64 v[94:95], 0
    v_mov_b64 v[96:97], 0
    v_mov_b64 v[98:99], 0
    v_mov_b64 v[100:101], 0
    v_mov_b64 v[102:103], 0
    v_mov_b64 v[104:105], 0
    v_mov_b64 v[106:107], 0
    v_mov_b64 v[108:109], 0
    v_mov_b64 v[110:111], 0
    v_mov_b64 v[112:113], 0
    v_mov_b64 v[114:115], 0
    v_mov_b64 v[116:117], 0
    v_mov_b64 v[118:119], 0
    v_mov_b64 v[120:121], 0
    v_mov_b64 v[122:123], 0
    v_mov_b64 v[124:125], 0
    v_mov_b64 v[126:127], 0
    v_mov_b64 v[128:129], 0
    v_mov_b64 v[130:131], 0
    v_mov_b64 v[132:133], 0
    v_mov_b64 v[134:135], 0
    v_mov_b64 v[136:137], 0
    v_mov_b64 v[138:139], 0
    v_mov_b64 v[140:141], 0
    v_mov_b64 v[142:143], 0
    v_lshrrev_b32 v12, 3, v2
    v_lshlrev_b32 v213, 10, v12
    v_and_b32 v12, 7, v2
    v_bfe_u32 v13, v2, 4, 1
    v_lshlrev_b32 v13, 2, v13
    v_xor_b32 v12, v12, v13
    v_lshl_add_u32 v213, v12, 4, v213
    v_and_b32 v12, 7, v2
    v_lshlrev_b32 v214, 10, v12
    v_lshrrev_b32 v12, 3, v2
    v_lshlrev_b32 v245, 4, v12
    v_add_u32 v214, v245, v214
    v_lshlrev_b32 v244, 1, v0
    v_mul_u32_u24 v215, 3584, v0
    s_mul_i32 s60, s29, 28
    s_add_u32 s60, s60, s30
    s_lshl_b32 s61, s28, 16
    s_lshl_b32 s33, s32, 7
    s_add_u32 s61, s61, s33
    s_lshl_b32 s62, s28, 13
    s_add_u32 s62, s62, 65536
    s_lshl_b32 s63, s32, 7
    s_lshl_b32 s64, s31, 16
    s_lshl_b32 s33, s34, 15
    s_add_u32 s64, s64, s33
    s_lshl_b32 s33, s35, 13
    s_add_u32 s64, s64, s33
    s_add_u32 s64, s64, s63
    s_cmp_lt_u32 s30, 28
    s_cselect_b32 s65, 0x1c0000, 0
    s_cmp_lg_u32 s28, 4
    s_cbranch_scc1 L_K
    v_bfe_u32 v8, v2, 4, 1
    v_lshlrev_b32 v8, 14, v8
    v_and_b32 v9, 15, v2
    v_lshl_add_u32 v12, v9, 7, v8
    s_mov_b32 s53, 0
L_npoll:
    buffer_load_dwordx4 v[8:11], v12, s[24:27], s44 offen sc1
    s_add_u32 s53, s53, 1
    s_waitcnt vmcnt(0)
    v_cmp_eq_u32 vcc, -1, v8
    s_cmp_gt_u32 s53, 200000
    s_cbranch_scc1 L_ndone
    s_cbranch_vccnz L_npoll
L_ndone:
    v_max_u32 v8, v8, v9
    v_max3_u32 v8, v8, v10, v11
    v_lshrrev_b32 v9, 4, v2
    v_lshlrev_b32 v9, 2, v9
    v_max_u32_dpp v8, v8, v8 row_ror:8 row_mask:0xf bank_mask:0xf
    s_nop 1
    v_max_u32_dpp v8, v8, v8 row_ror:4 row_mask:0xf bank_mask:0xf
    s_nop 1
    v_max_u32_dpp v8, v8, v8 row_ror:2 row_mask:0xf bank_mask:0xf
    s_nop 1
    v_max_u32_dpp v8, v8, v8 row_ror:1 row_mask:0xf bank_mask:0xf
    s_nop 1
    v_add_u32 v9, 0x26e30, v9
    ds_write_b32 v9, v8
L_K:
    s_lshl_b32 s33, s34, 12
    v_add_u32 v12, s33, v7
    v_mov_b32 v13, 0x26e20
    s_waitcnt lgkmcnt(0)
    s_barrier
    s_add_u32 s48, s42, s45
    s_add_u32 s49, s43, s45
    buffer_load_dwordx4 v[160:163], v4, s[24:27], s48 offen sc1
    s_mov_b64 exec, s[46:47]
    buffer_load_dwordx4 v[176:179], v5, s[24:27], s49 offen sc1
    buffer_load_dwordx4 v[180:183], v5, s[24:27], s49 offen offset:512 sc1
    s_mov_b64 exec, -1
    s_add_u32 s45, s45, 1024
    s_and_b32 s45, s45, 0x3fff
    ds_read_b128 v[8:11], v13
    ds_read_b64 v[14:15], v13 offset:16
    ds_read_b128 v[144:147], v12 offset:40960
    ds_read_b128 v[148:151], v12 offset:41984
    ds_read_b128 v[152:155], v12 offset:43008
    ds_read_b128 v[156:159], v12 offset:44032
    s_add_u32 s48, s42, s45
    s_add_u32 s49, s43, s45
    buffer_load_dwordx4 v[164:167], v4, s[24:27], s48 offen sc1
    s_mov_b64 exec, s[46:47]
    buffer_load_dwordx4 v[184:187], v5, s[24:27], s49 offen sc1
    buffer_load_dwordx4 v[188:191], v5, s[24:27], s49 offen offset:512 sc1
    s_mov_b64 exec, -1
    s_add_u32 s45, s45, 1024
    s_and_b32 s45, s45, 0x3fff
    s_add_u32 s48, s42, s45
    s_add_u32 s49, s43, s45
    buffer_load_dwordx4 v[168:171], v4, s[24:27], s48 offen sc1
    s_mov_b64 exec, s[46:47]
    buffer_load_dwordx4 v[192:195], v5, s[24:27], s49 offen sc1
    buffer_load_dwordx4 v[196:199], v5, s[24:27], s49 offen offset:512 sc1
    s_mov_b64 exec, -1
    s_add_u32 s45, s45, 1024
    s_and_b32 s45, s45, 0x3fff
    s_waitcnt lgkmcnt(0)
    v_max_u32 v8, v8, v9
    v_max3_u32 v8, v8, v10, v11
    v_mul_f32 v8, v8, v14
    v_readfirstlane_b32 s51, v15
    v_readfirstlane_b32 s50, v8
    s_nop 3
    s_cmp_gt_u32 s50, 0x451c4000
    s_cbranch_scc1 L_slow
    s_cmp_gt_u32 s51, 0x7b800000
    s_cbranch_scc1 L_slow
    s_waitcnt vmcnt(8)
    v_mfma_f32_32x32x16_bf16 v[16:31], v[160:163], v[144:147], 0
    s_setprio 2
    s_nop 10
    v_mfma_f32_32x32x16_bf16 v[32:47], v[160:163], v[148:151], 0
    v_exp_f32 v16, v16
    v_exp_f32 v17, v17
    v_exp_f32 v18, v18
    v_exp_f32 v19, v19
    v_exp_f32 v20, v20
    v_exp_f32 v21, v21
    v_exp_f32 v22, v22
    v_exp_f32 v23, v23
    v_exp_f32 v24, v24
    v_exp_f32 v25, v25
    v_exp_f32 v26, v26
    v_exp_f32 v27, v27
    v_exp_f32 v28, v28
    v_exp_f32 v29, v29
    v_exp_f32 v30, v30
    v_exp_f32 v31, v31
    s_add_u32 s48, s42, s45
    s_add_u32 s49, s43, s45
    buffer_load_dwordx4 v[172:175], v4, s[24:27], s48 offen sc1
    s_mov_b64 exec, s[46:47]
    buffer_load_dwordx4 v[200:203], v5, s[24:27], s49 offen sc1
    buffer_load_dwordx4 v[204:207], v5, s[24:27], s49 offen offset:512 sc1
    s_mov_b64 exec, -1
    s_add_u32 s45, s45, 1024
    s_and_b32 s45, s45, 0x3fff
    s_waitcnt vmcnt(9)
    v_mfma_f32_32x32x16_bf16 v[48:63], v[160:163], v[152:155], 0
    v_exp_f32 v32, v32
    v_exp_f32 v33, v33
    v_exp_f32 v34, v34
    v_exp_f32 v35, v35
    v_exp_f32 v36, v36
    v_smfmac_f32_32x32x32_bf16 v[80:95], v[176:179], v[16:23], v208
    v_exp_f32 v37, v37
    v_exp_f32 v38, v38
    v_exp_f32 v39, v39
    v_exp_f32 v40, v40
    v_exp_f32 v41, v41
    v_smfmac_f32_32x32x32_bf16 v[80:95], v[180:183], v[24:31], v208
    v_exp_f32 v42, v42
    v_exp_f32 v43, v43
    v_exp_f32 v44, v44
    v_exp_f32 v45, v45
    v_exp_f32 v46, v46
    v_exp_f32 v47, v47
    v_mfma_f32_32x32x16_bf16 v[64:79], v[160:163], v[156:159], 0
    v_exp_f32 v48, v48
    v_exp_f32 v49, v49
    v_exp_f32 v50, v50
    v_exp_f32 v51, v51
    v_exp_f32 v52, v52
    v_smfmac_f32_32x32x32_bf16 v[96:111], v[176:179], v[32:39], v208
    v_exp_f32 v53, v53
    v_exp_f32 v54, v54
    v_exp_f32 v55, v55
    v_exp_f32 v56, v56
    v_exp_f32 v57, v57
    v_smfmac_f32_32x32x32_bf16 v[96:111], v[180:183], v[40:47], v208
    v_exp_f32 v58, v58
    v_exp_f32 v59, v59
    v_exp_f32 v60, v60
    v_exp_f32 v61, v61
    v_exp_f32 v62, v62
    v_exp_f32 v63, v63
    s_waitcnt vmcnt(6)
    v_mfma_f32_32x32x16_bf16 v[16:31], v[164:167], v[144:147], 0
    v_exp_f32 v64, v64
    v_exp_f32 v65, v65
    v_exp_f32 v66, v66
    v_exp_f32 v67, v67
    v_exp_f32 v68, v68
    v_smfmac_f32_32x32x32_bf16 v[112:127], v[176:179], v[48:55], v208
    v_exp_f32 v69, v69
    v_exp_f32 v70, v70
    v_exp_f32 v71, v71
    v_exp_f32 v72, v72
    v_exp_f32 v73, v73
    v_smfmac_f32_32x32x32_bf16 v[112:127], v[180:183], v[56:63], v208
    v_exp_f32 v74, v74
    v_exp_f32 v75, v75
    v_exp_f32 v76, v76
    v_exp_f32 v77, v77
    v_exp_f32 v78, v78
    v_exp_f32 v79, v79
    v_mfma_f32_32x32x16_bf16 v[32:47], v[164:167], v[148:151], 0
    v_exp_f32 v16, v16
    v_exp_f32 v17, v17
    v_exp_f32 v18, v18
    v_exp_f32 v19, v19
    v_exp_f32 v20, v20
    v_smfmac_f32_32x32x32_bf16 v[128:143], v[176:179], v[64:71], v208
    v_exp_f32 v21, v21
    v_exp_f32 v22, v22
    v_exp_f32 v23, v23
    v_exp_f32 v24, v24
    v_exp_f32 v25, v25
    v_smfmac_f32_32x32x32_bf16 v[128:143], v[180:183], v[72:79], v208
    v_exp_f32 v26, v26
    v_exp_f32 v27, v27
    v_exp_f32 v28, v28
    v_exp_f32 v29, v29
    v_exp_f32 v30, v30
    v_exp_f32 v31, v31
    s_add_u32 s48, s42, s45
    s_add_u32 s49, s43, s45
    buffer_load_dwordx4 v[160:163], v4, s[24:27], s48 offen sc1
    s_mov_b64 exec, s[46:47]
    buffer_load_dwordx4 v[176:179], v5, s[24:27], s49 offen sc1
    buffer_load_dwordx4 v[180:183], v5, s[24:27], s49 offen offset:512 sc1
    s_mov_b64 exec, -1
    s_add_u32 s45, s45, 1024
    s_and_b32 s45, s45, 0x3fff
    v_mfma_f32_32x32x16_bf16 v[48:63], v[164:167], v[152:155], 0
    v_exp_f32 v32, v32
    v_exp_f32 v33, v33
    v_exp_f32 v34, v34
    v_exp_f32 v35, v35
    v_exp_f32 v36, v36
    v_smfmac_f32_32x32x32_bf16 v[80:95], v[184:187], v[16:23], v208
    v_exp_f32 v37, v37
    v_exp_f32 v38, v38
    v_exp_f32 v39, v39
    v_exp_f32 v40, v40
    v_exp_f32 v41, v41
    v_smfmac_f32_32x32x32_bf16 v[80:95], v[188:191], v[24:31], v208
    v_exp_f32 v42, v42
    v_exp_f32 v43, v43
    v_exp_f32 v44, v44
    v_exp_f32 v45, v45
    v_exp_f32 v46, v46
    v_exp_f32 v47, v47
    s_mov_b32 s20, s6
    s_and_b32 s21, s7, 0xffff
    s_mov_b32 s22, 0x80000
    s_add_u32 m0, s62, 0
    s_add_u32 s33, s61, 0
    buffer_load_dwordx4 v213, s[20:23], s33 offen lds
    v_mfma_f32_32x32x16_bf16 v[64:79], v[164:167], v[156:159], 0
    v_exp_f32 v48, v48
    v_exp_f32 v49, v49
    v_exp_f32 v50, v50
    v_exp_f32 v51, v51
    v_exp_f32 v52, v52
    v_smfmac_f32_32x32x32_bf16 v[96:111], v[184:187], v[32:39], v208
    v_exp_f32 v53, v53
    v_exp_f32 v54, v54
    v_exp_f32 v55, v55
    v_exp_f32 v56, v56
    v_exp_f32 v57, v57
    v_smfmac_f32_32x32x32_bf16 v[96:111], v[188:191], v[40:47], v208
    v_exp_f32 v58, v58
    v_exp_f32 v59, v59
    v_exp_f32 v60, v60
    v_exp_f32 v61, v61
    v_exp_f32 v62, v62
    v_exp_f32 v63, v63
    s_mov_b32 s20, s6
    s_and_b32 s21, s7, 0xffff
    s_mov_b32 s22, 0x80000
    s_add_u32 m0, s62, 1024
    s_add_u32 s33, s61, 8192
    buffer_load_dwordx4 v213, s[20:23], s33 offen lds
    s_waitcnt vmcnt(8)
    v_mfma_f32_32x32x16_bf16 v[16:31], v[168:171], v[144:147], 0
    v_exp_f32 v64, v64
    v_exp_f32 v65, v65
    v_exp_f32 v66, v66
    v_exp_f32 v67, v67
    v_exp_f32 v68, v68
    v_smfmac_f32_32x32x32_bf16 v[112:127], v[184:187], v[48:55], v208
    v_exp_f32 v69, v69
    v_exp_f32 v70, v70
    v_exp_f32 v71, v71
    v_exp_f32 v72, v72
    v_exp_f32 v73, v73
    v_smfmac_f32_32x32x32_bf16 v[112:127], v[188:191], v[56:63], v208
    v_exp_f32 v74, v74
    v_exp_f32 v75, v75
    v_exp_f32 v76, v76
    v_exp_f32 v77, v77
    v_exp_f32 v78, v78
    v_exp_f32 v79, v79
    v_mfma_f32_32x32x16_bf16 v[32:47], v[168:171], v[148:151], 0
    v_exp_f32 v16, v16
    v_exp_f32 v17, v17
    v_exp_f32 v18, v18
    v_exp_f32 v19, v19
    v_exp_f32 v20, v20
    v_smfmac_f32_32x32x32_bf16 v[128:143], v[184:187], v[64:71], v208
    v_exp_f32 v21, v21
    v_exp_f32 v22, v22
    v_exp_f32 v23, v23
    v_exp_f32 v24, v24
    v_exp_f32 v25, v25
    v_smfmac_f32_32x32x32_bf16 v[128:143], v[188:191], v[72:79], v208
    v_exp_f32 v26, v26
    v_exp_f32 v27, v27
    v_exp_f32 v28, v28
    v_exp_f32 v29, v29
    v_exp_f32 v30, v30
    v_exp_f32 v31, v31
    s_add_u32 s48, s42, s45
    s_add_u32 s49, s43, s45
    buffer_load_dwordx4 v[164:167], v4, s[24:27], s48 offen sc1
    s_mov_b64 exec, s[46:47]
    buffer_load_dwordx4 v[184:187], v5, s[24:27], s49 offen sc1
    buffer_load_dwordx4 v[188:191], v5, s[24:27], s49 offen offset:512 sc1
    s_mov_b64 exec, -1
    s_add_u32 s45, s45, 1024
    s_and_b32 s45, s45, 0x3fff
    s_cmp_lg_u32 s28, 0
    s_cbranch_scc1 L_gu0_0
    s_mov_b32 s20, s10
    s_and_b32 s21, s11, 0xffff
    s_mov_b32 s22, s65
    s_lshl_b32 s33, s28, 10
    s_add_u32 m0, s33, 144384
    s_lshl_b32 s33, s60, 4
    buffer_load_dwordx4 v215, s[20:23], s33 offen lds
L_gu0_0:
    v_mfma_f32_32x32x16_bf16 v[48:63], v[168:171], v[152:155], 0
    v_exp_f32 v32, v32
    v_exp_f32 v33, v33
    v_exp_f32 v34, v34
    v_exp_f32 v35, v35
    v_exp_f32 v36, v36
    v_smfmac_f32_32x32x32_bf16 v[80:95], v[192:195], v[16:23], v208
    v_exp_f32 v37, v37
    v_exp_f32 v38, v38
    v_exp_f32 v39, v39
    v_exp_f32 v40, v40
    v_exp_f32 v41, v41
    v_smfmac_f32_32x32x32_bf16 v[80:95], v[196:199], v[24:31], v208
    v_exp_f32 v42, v42
    v_exp_f32 v43, v43
    v_exp_f32 v44, v44
    v_exp_f32 v45, v45
    v_exp_f32 v46, v46
    v_exp_f32 v47, v47
    s_mov_b32 s20, s6
    s_and_b32 s21, s7, 0xffff
    s_mov_b32 s22, 0x80000
    s_add_u32 m0, s62, 2048
    s_add_u32 s33, s61, 16384
    buffer_load_dwordx4 v213, s[20:23], s33 offen lds
    v_mfma_f32_32x32x16_bf16 v[64:79], v[168:171], v[156:159], 0
    v_exp_f32 v48, v48
    v_exp_f32 v49, v49
    v_exp_f32 v50, v50
    v_exp_f32 v51, v51
    v_exp_f32 v52, v52
    v_smfmac_f32_32x32x32_bf16 v[96:111], v[192:195], v[32:39], v208
    v_exp_f32 v53, v53
    v_exp_f32 v54, v54
    v_exp_f32 v55, v55
    v_exp_f32 v56, v56
    v_exp_f32 v57, v57
    v_smfmac_f32_32x32x32_bf16 v[96:111], v[196:199], v[40:47], v208
    v_exp_f32 v58, v58
    v_exp_f32 v59, v59
    v_exp_f32 v60, v60
    v_exp_f32 v61, v61
    v_exp_f32 v62, v62
    v_exp_f32 v63, v63
    s_mov_b32 s20, s6
    s_and_b32 s21, s7, 0xffff
    s_mov_b32 s22, 0x80000
    s_add_u32 m0, s62, 3072
    s_add_u32 s33, s61, 24576
    buffer_load_dwordx4 v213, s[20:23], s33 offen lds
    s_cmp_lg_u32 s28, 4
    s_cbranch_scc1 L_gu0_4
    s_mov_b32 s20, s10
    s_and_b32 s21, s11, 0xffff
    s_mov_b32 s22, s65
    s_lshl_b32 s33, s28, 10
    s_add_u32 m0, s33, 144384
    s_lshl_b32 s33, s60, 4
    buffer_load_dwordx4 v215, s[20:23], s33 offen lds
L_gu0_4:
    s_waitcnt vmcnt(10)
    v_mfma_f32_32x32x16_bf16 v[16:31], v[172:175], v[144:147], 0
    v_exp_f32 v64, v64
    v_exp_f32 v65, v65
    v_exp_f32 v66, v66
    v_exp_f32 v67, v67
    v_exp_f32 v68, v68
    v_smfmac_f32_32x32x32_bf16 v[112:127], v[192:195], v[48:55], v208
    v_exp_f32 v69, v69
    v_exp_f32 v70, v70
    v_exp_f32 v71, v71
    v_exp_f32 v72, v72
    v_exp_f32 v73, v73
    v_smfmac_f32_32x32x32_bf16 v[112:127], v[196:199], v[56:63], v208
    v_exp_f32 v74, v74
    v_exp_f32 v75, v75
    v_exp_f32 v76, v76
    v_exp_f32 v77, v77
    v_exp_f32 v78, v78
    v_exp_f32 v79, v79
    v_mfma_f32_32x32x16_bf16 v[32:47], v[172:175], v[148:151], 0
    v_exp_f32 v16, v16
    v_exp_f32 v17, v17
    v_exp_f32 v18, v18
    v_exp_f32 v19, v19
    v_exp_f32 v20, v20
    v_smfmac_f32_32x32x32_bf16 v[128:143], v[192:195], v[64:71], v208
    v_exp_f32 v21, v21
    v_exp_f32 v22, v22
    v_exp_f32 v23, v23
    v_exp_f32 v24, v24
    v_exp_f32 v25, v25
    v_smfmac_f32_32x32x32_bf16 v[128:143], v[196:199], v[72:79], v208
    v_exp_f32 v26, v26
    v_exp_f32 v27, v27
    v_exp_f32 v28, v28
    v_exp_f32 v29, v29
    v_exp_f32 v30, v30
    v_exp_f32 v31, v31
    s_add_u32 s48, s42, s45
    s_add_u32 s49, s43, s45
    buffer_load_dwordx4 v[168:171], v4, s[24:27], s48 offen sc1
    s_mov_b64 exec, s[46:47]
    buffer_load_dwordx4 v[192:195], v5, s[24:27], s49 offen sc1
    buffer_load_dwordx4 v[196:199], v5, s[24:27], s49 offen offset:512 sc1
    s_mov_b64 exec, -1
    s_add_u32 s45, s45, 1024
    s_and_b32 s45, s45, 0x3fff
    s_cmp_lg_u32 s28, 1
    s_cbranch_scc1 L_gu0_1
    s_mov_b32 s20, s10
    s_and_b32 s21, s11, 0xffff
    s_mov_b32 s22, s65
    s_lshl_b32 s33, s28, 10
    s_add_u32 m0, s33, 144384
    s_lshl_b32 s33, s60, 4
    buffer_load_dwordx4 v215, s[20:23], s33 offen lds
L_gu0_1:
    v_mfma_f32_32x32x16_bf16 v[48:63], v[172:175], v[152:155], 0
    v_exp_f32 v32, v32
    v_exp_f32 v33, v33
    v_exp_f32 v34, v34
    v_exp_f32 v35, v35
    v_exp_f32 v36, v36
    v_smfmac_f32_32x32x32_bf16 v[80:95], v[200:203], v[16:23], v208
    v_exp_f32 v37, v37
    v_exp_f32 v38, v38
    v_exp_f32 v39, v39
    v_exp_f32 v40, v40
    v_exp_f32 v41, v41
    v_smfmac_f32_32x32x32_bf16 v[80:95], v[204:207], v[24:31], v208
    v_exp_f32 v42, v42
    v_exp_f32 v43, v43
    v_exp_f32 v44, v44
    v_exp_f32 v45, v45
    v_exp_f32 v46, v46
    v_exp_f32 v47, v47
    s_mov_b32 s20, s6
    s_and_b32 s21, s7, 0xffff
    s_mov_b32 s22, 0x80000
    s_add_u32 m0, s62, 4096
    s_add_u32 s33, s61, 32768
    buffer_load_dwordx4 v213, s[20:23], s33 offen lds
    v_mfma_f32_32x32x16_bf16 v[64:79], v[172:175], v[156:159], 0
    v_exp_f32 v48, v48
    v_exp_f32 v49, v49
    v_exp_f32 v50, v50
    v_exp_f32 v51, v51
    v_exp_f32 v52, v52
    v_smfmac_f32_32x32x32_bf16 v[96:111], v[200:203], v[32:39], v208
    v_exp_f32 v53, v53
    v_exp_f32 v54, v54
    v_exp_f32 v55, v55
    v_exp_f32 v56, v56
    v_exp_f32 v57, v57
    v_smfmac_f32_32x32x32_bf16 v[96:111], v[204:207], v[40:47], v208
    v_exp_f32 v58, v58
    v_exp_f32 v59, v59
    v_exp_f32 v60, v60
    v_exp_f32 v61, v61
    v_exp_f32 v62, v62
    v_exp_f32 v63, v63
    s_mov_b32 s20, s6
    s_and_b32 s21, s7, 0xffff
    s_mov_b32 s22, 0x80000
    s_add_u32 m0, s62, 5120
    s_add_u32 s33, s61, 40960
    buffer_load_dwordx4 v213, s[20:23], s33 offen lds
    s_cmp_lg_u32 s28, 5
    s_cbranch_scc1 L_gu0_5
    s_mov_b32 s20, s10
    s_and_b32 s21, s11, 0xffff
    s_mov_b32 s22, s65
    s_lshl_b32 s33, s28, 10
    s_add_u32 m0, s33, 144384
    s_lshl_b32 s33, s60, 4
    buffer_load_dwordx4 v215, s[20:23], s33 offen lds
L_gu0_5:
    s_waitcnt vmcnt(12)
    v_mfma_f32_32x32x16_bf16 v[16:31], v[160:163], v[144:147], 0
    v_exp_f32 v64, v64
    v_exp_f32 v65, v65
    v_exp_f32 v66, v66
    v_exp_f32 v67, v67
    v_exp_f32 v68, v68
    v_smfmac_f32_32x32x32_bf16 v[112:127], v[200:203], v[48:55], v208
    v_exp_f32 v69, v69
    v_exp_f32 v70, v70
    v_exp_f32 v71, v71
    v_exp_f32 v72, v72
    v_exp_f32 v73, v73
    v_smfmac_f32_32x32x32_bf16 v[112:127], v[204:207], v[56:63], v208
    v_exp_f32 v74, v74
    v_exp_f32 v75, v75
    v_exp_f32 v76, v76
    v_exp_f32 v77, v77
    v_exp_f32 v78, v78
    v_exp_f32 v79, v79
    v_mfma_f32_32x32x16_bf16 v[32:47], v[160:163], v[148:151], 0
    v_exp_f32 v16, v16
    v_exp_f32 v17, v17
    v_exp_f32 v18, v18
    v_exp_f32 v19, v19
    v_exp_f32 v20, v20
    v_smfmac_f32_32x32x32_bf16 v[128:143], v[200:203], v[64:71], v208
    v_exp_f32 v21, v21
    v_exp_f32 v22, v22
    v_exp_f32 v23, v23
    v_exp_f32 v24, v24
    v_exp_f32 v25, v25
    v_smfmac_f32_32x32x32_bf16 v[128:143], v[204:207], v[72:79], v208
    v_exp_f32 v26, v26
    v_exp_f32 v27, v27
    v_exp_f32 v28, v28
    v_exp_f32 v29, v29
    v_exp_f32 v30, v30
    v_exp_f32 v31, v31
    s_add_u32 s48, s42, s45
    s_add_u32 s49, s43, s45
    buffer_load_dwordx4 v[172:175], v4, s[24:27], s48 offen sc1
    s_mov_b64 exec, s[46:47]
    buffer_load_dwordx4 v[200:203], v5, s[24:27], s49 offen sc1
    buffer_load_dwordx4 v[204:207], v5, s[24:27], s49 offen offset:512 sc1
    s_mov_b64 exec, -1
    s_add_u32 s45, s45, 1024
    s_and_b32 s45, s45, 0x3fff
    s_cmp_lg_u32 s28, 2
    s_cbranch_scc1 L_gu0_2
    s_mov_b32 s20, s10
    s_and_b32 s21, s11, 0xffff
    s_mov_b32 s22, s65
    s_lshl_b32 s33, s28, 10
    s_add_u32 m0, s33, 144384
    s_lshl_b32 s33, s60, 4
    buffer_load_dwordx4 v215, s[20:23], s33 offen lds
L_gu0_2:
    v_mfma_f32_32x32x16_bf16 v[48:63], v[160:163], v[152:155], 0
    v_exp_f32 v32, v32
    v_exp_f32 v33, v33
    v_exp_f32 v34, v34
    v_exp_f32 v35, v35
    v_exp_f32 v36, v36
    v_smfmac_f32_32x32x32_bf16 v[80:95], v[176:179], v[16:23], v208
    v_exp_f32 v37, v37
    v_exp_f32 v38, v38
    v_exp_f32 v39, v39
    v_exp_f32 v40, v40
    v_exp_f32 v41, v41
    v_smfmac_f32_32x32x32_bf16 v[80:95], v[180:183], v[24:31], v208
    v_exp_f32 v42, v42
    v_exp_f32 v43, v43
    v_exp_f32 v44, v44
    v_exp_f32 v45, v45
    v_exp_f32 v46, v46
    v_exp_f32 v47, v47
    s_mov_b32 s20, s6
    s_and_b32 s21, s7, 0xffff
    s_mov_b32 s22, 0x80000
    s_add_u32 m0, s62, 6144
    s_add_u32 s33, s61, 49152
    buffer_load_dwordx4 v213, s[20:23], s33 offen lds
    v_mfma_f32_32x32x16_bf16 v[64:79], v[160:163], v[156:159], 0
    v_exp_f32 v48, v48
    v_exp_f32 v49, v49
    v_exp_f32 v50, v50
    v_exp_f32 v51, v51
    v_exp_f32 v52, v52
    v_smfmac_f32_32x32x32_bf16 v[96:111], v[176:179], v[32:39], v208
    v_exp_f32 v53, v53
    v_exp_f32 v54, v54
    v_exp_f32 v55, v55
    v_exp_f32 v56, v56
    v_exp_f32 v57, v57
    v_smfmac_f32_32x32x32_bf16 v[96:111], v[180:183], v[40:47], v208
    v_exp_f32 v58, v58
    v_exp_f32 v59, v59
    v_exp_f32 v60, v60
    v_exp_f32 v61, v61
    v_exp_f32 v62, v62
    v_exp_f32 v63, v63
    s_mov_b32 s20, s6
    s_and_b32 s21, s7, 0xffff
    s_mov_b32 s22, 0x80000
    s_add_u32 m0, s62, 7168
    s_add_u32 s33, s61, 57344
    buffer_load_dwordx4 v213, s[20:23], s33 offen lds
    s_cmp_lg_u32 s28, 6
    s_cbranch_scc1 L_gu0_6
    s_mov_b32 s20, s10
    s_and_b32 s21, s11, 0xffff
    s_mov_b32 s22, s65
    s_lshl_b32 s33, s28, 10
    s_add_u32 m0, s33, 144384
    s_lshl_b32 s33, s60, 4
    buffer_load_dwordx4 v215, s[20:23], s33 offen lds
L_gu0_6:
    s_waitcnt vmcnt(12)
    v_mfma_f32_32x32x16_bf16 v[16:31], v[164:167], v[144:147], 0
    v_exp_f32 v64, v64
    v_exp_f32 v65, v65
    v_exp_f32 v66, v66
    v_exp_f32 v67, v67
    v_exp_f32 v68, v68
    v_smfmac_f32_32x32x32_bf16 v[112:127], v[176:179], v[48:55], v208
    v_exp_f32 v69, v69
    v_exp_f32 v70, v70
    v_exp_f32 v71, v71
    v_exp_f32 v72, v72
    v_exp_f32 v73, v73
    v_smfmac_f32_32x32x32_bf16 v[112:127], v[180:183], v[56:63], v208
    v_exp_f32 v74, v74
    v_exp_f32 v75, v75
    v_exp_f32 v76, v76
    v_exp_f32 v77, v77
    v_exp_f32 v78, v78
    v_exp_f32 v79, v79
    s_setprio 1
    v_mfma_f32_32x32x16_bf16 v[32:47], v[164:167], v[148:151], 0
    v_exp_f32 v16, v16
    v_exp_f32 v17, v17
    v_exp_f32 v18, v18
    v_exp_f32 v19, v19
    v_exp_f32 v20, v20
    v_smfmac_f32_32x32x32_bf16 v[128:143], v[176:179], v[64:71], v208
    v_exp_f32 v21, v21
    v_exp_f32 v22, v22
    v_exp_f32 v23, v23
    v_exp_f32 v24, v24
    v_exp_f32 v25, v25
    v_smfmac_f32_32x32x32_bf16 v[128:143], v[180:183], v[72:79], v208
    v_exp_f32 v26, v26
    v_exp_f32 v27, v27
    v_exp_f32 v28, v28
    v_exp_f32 v29, v29
    v_exp_f32 v30, v30
    v_exp_f32 v31, v31
    s_add_u32 s48, s42, s45
    s_add_u32 s49, s43, s45
    buffer_load_dwordx4 v[160:163], v4, s[24:27], s48 offen sc1
    s_mov_b64 exec, s[46:47]
    buffer_load_dwordx4 v[176:179], v5, s[24:27], s49 offen sc1
    buffer_load_dwordx4 v[180:183], v5, s[24:27], s49 offen offset:512 sc1
    s_mov_b64 exec, -1
    s_add_u32 s45, s45, 1024
    s_and_b32 s45, s45, 0x3fff
    s_cmp_lg_u32 s28, 3
    s_cbranch_scc1 L_gu0_3
    s_mov_b32 s20, s10
    s_and_b32 s21, s11, 0xffff
    s_mov_b32 s22, s65
    s_lshl_b32 s33, s28, 10
    s_add_u32 m0, s33, 144384
    s_lshl_b32 s33, s60, 4
    buffer_load_dwordx4 v215, s[20:23], s33 offen lds
L_gu0_3:
    v_mfma_f32_32x32x16_bf16 v[48:63], v[164:167], v[152:155], 0
    v_exp_f32 v32, v32
    v_exp_f32 v33, v33
    v_exp_f32 v34, v34
    v_exp_f32 v35, v35
    v_exp_f32 v36, v36
    v_smfmac_f32_32x32x32_bf16 v[80:95], v[184:187], v[16:23], v208
    v_exp_f32 v37, v37
    v_exp_f32 v38, v38
    v_exp_f32 v39, v39
    v_exp_f32 v40, v40
    v_exp_f32 v41, v41
    v_smfmac_f32_32x32x32_bf16 v[80:95], v[188:191], v[24:31], v208
    v_exp_f32 v42, v42
    v_exp_f32 v43, v43
    v_exp_f32 v44, v44
    v_exp_f32 v45, v45
    v_exp_f32 v46, v46
    v_exp_f32 v47, v47
    s_mov_b32 s20, s4
    s_and_b32 s21, s5, 0xffff
    s_mov_b32 s22, 0x200000
    buffer_load_dwordx4 v[216:219], v214, s[20:23], s64 offen
    v_mfma_f32_32x32x16_bf16 v[64:79], v[164:167], v[156:159], 0
    v_exp_f32 v48, v48
    v_exp_f32 v49, v49
    v_exp_f32 v50, v50
    v_exp_f32 v51, v51
    v_exp_f32 v52, v52
    v_smfmac_f32_32x32x32_bf16 v[96:111], v[184:187], v[32:39], v208
    v_exp_f32 v53, v53
    v_exp_f32 v54, v54
    v_exp_f32 v55, v55
    v_exp_f32 v56, v56
    v_exp_f32 v57, v57
    v_smfmac_f32_32x32x32_bf16 v[96:111], v[188:191], v[40:47], v208
    v_exp_f32 v58, v58
    v_exp_f32 v59, v59
    v_exp_f32 v60, v60
    v_exp_f32 v61, v61
    v_exp_f32 v62, v62
    v_exp_f32 v63, v63
    s_mov_b32 s20, s8
    s_and_b32 s21, s9, 0xffff
    s_mov_b32 s22, 1024
    buffer_load_dwordx4 v[220:223], v245, s[20:23], s63 offen
    s_cmp_lg_u32 s28, 7
    s_cbranch_scc1 L_gu0_7
    s_mov_b32 s20, s10
    s_and_b32 s21, s11, 0xffff
    s_mov_b32 s22, s65
    s_lshl_b32 s33, s28, 10
    s_add_u32 m0, s33, 144384
    s_lshl_b32 s33, s60, 4
    buffer_load_dwordx4 v215, s[20:23], s33 offen lds
L_gu0_7:
    s_waitcnt vmcnt(12)
    v_mfma_f32_32x32x16_bf16 v[16:31], v[168:171], v[144:147], 0
    v_exp_f32 v64, v64
    v_exp_f32 v65, v65
    v_exp_f32 v66, v66
    v_exp_f32 v67, v67
    v_exp_f32 v68, v68
    v_smfmac_f32_32x32x32_bf16 v[112:127], v[184:187], v[48:55], v208
    v_exp_f32 v69, v69
    v_exp_f32 v70, v70
    v_exp_f32 v71, v71
    v_exp_f32 v72, v72
    v_exp_f32 v73, v73
    v_smfmac_f32_32x32x32_bf16 v[112:127], v[188:191], v[56:63], v208
    v_exp_f32 v74, v74
    v_exp_f32 v75, v75
    v_exp_f32 v76, v76
    v_exp_f32 v77, v77
    v_exp_f32 v78, v78
    v_exp_f32 v79, v79
    v_mfma_f32_32x32x16_bf16 v[32:47], v[168:171], v[148:151], 0
    v_exp_f32 v16, v16
    v_exp_f32 v17, v17
    v_exp_f32 v18, v18
    v_exp_f32 v19, v19
    v_exp_f32 v20, v20
    v_smfmac_f32_32x32x32_bf16 v[128:143], v[184:187], v[64:71], v208
    v_exp_f32 v21, v21
    v_exp_f32 v22, v22
    v_exp_f32 v23, v23
    v_exp_f32 v24, v24
    v_exp_f32 v25, v25
    v_smfmac_f32_32x32x32_bf16 v[128:143], v[188:191], v[72:79], v208
    v_exp_f32 v26, v26
    v_exp_f32 v27, v27
    v_exp_f32 v28, v28
    v_exp_f32 v29, v29
    v_exp_f32 v30, v30
    v_exp_f32 v31, v31
    s_add_u32 s48, s42, s45
    s_add_u32 s49, s43, s45
    buffer_load_dwordx4 v[164:167], v4, s[24:27], s48 offen sc1
    s_mov_b64 exec, s[46:47]
    buffer_load_dwordx4 v[184:187], v5, s[24:27], s49 offen sc1
    buffer_load_dwordx4 v[188:191], v5, s[24:27], s49 offen offset:512 sc1
    s_mov_b64 exec, -1
    s_add_u32 s45, s45, 1024
    s_and_b32 s45, s45, 0x3fff
    v_mfma_f32_32x32x16_bf16 v[48:63], v[168:171], v[152:155], 0
    v_exp_f32 v32, v32
    v_exp_f32 v33, v33
    v_exp_f32 v34, v34
    v_exp_f32 v35, v35
    v_exp_f32 v36, v36
    v_smfmac_f32_32x32x32_bf16 v[80:95], v[192:195], v[16:23], v208
    v_exp_f32 v37, v37
    v_exp_f32 v38, v38
    v_exp_f32 v39, v39
    v_exp_f32 v40, v40
    v_exp_f32 v41, v41
    v_smfmac_f32_32x32x32_bf16 v[80:95], v[196:199], v[24:31], v208
    v_exp_f32 v42, v42
    v_exp_f32 v43, v43
    v_exp_f32 v44, v44
    v_exp_f32 v45, v45
    v_exp_f32 v46, v46
    v_exp_f32 v47, v47
    s_mov_b32 s20, s8
    s_and_b32 s21, s9, 0xffff
    s_mov_b32 s22, 1024
    buffer_load_dwordx4 v[240:243], v7, s[20:23], 0 offen
    v_mfma_f32_32x32x16_bf16 v[64:79], v[168:171], v[156:159], 0
    v_exp_f32 v48, v48
    v_exp_f32 v49, v49
    v_exp_f32 v50, v50
    v_exp_f32 v51, v51
    v_exp_f32 v52, v52
    v_smfmac_f32_32x32x32_bf16 v[96:111], v[192:195], v[32:39], v208
    v_exp_f32 v53, v53
    v_exp_f32 v54, v54
    v_exp_f32 v55, v55
    v_exp_f32 v56, v56
    v_exp_f32 v57, v57
    v_smfmac_f32_32x32x32_bf16 v[96:111], v[196:199], v[40:47], v208
    v_exp_f32 v58, v58
    v_exp_f32 v59, v59
    v_exp_f32 v60, v60
    v_exp_f32 v61, v61
    v_exp_f32 v62, v62
    v_exp_f32 v63, v63
    s_mov_b32 s20, s14
    s_and_b32 s21, s15, 0xffff
    s_mov_b32 s22, s65
    s_lshl_b32 s33, s28, 10
    s_add_u32 m0, s33, 136192
    s_lshl_b32 s50, s60, 13
    s_add_u32 s33, s33, s50
    buffer_load_dwordx4 v7, s[20:23], s33 offen lds
    s_waitcnt vmcnt(12)
    v_mfma_f32_32x32x16_bf16 v[16:31], v[172:175], v[144:147], 0
    v_exp_f32 v64, v64
    v_exp_f32 v65, v65
    v_exp_f32 v66, v66
    v_exp_f32 v67, v67
    v_exp_f32 v68, v68
    v_smfmac_f32_32x32x32_bf16 v[112:127], v[192:195], v[48:55], v208
    v_exp_f32 v69, v69
    v_exp_f32 v70, v70
    v_exp_f32 v71, v71
    v_exp_f32 v72, v72
    v_exp_f32 v73, v73
    v_smfmac_f32_32x32x32_bf16 v[112:127], v[196:199], v[56:63], v208
    v_exp_f32 v74, v74
    v_exp_f32 v75, v75
    v_exp_f32 v76, v76
    v_exp_f32 v77, v77
    v_exp_f32 v78, v78
    v_exp_f32 v79, v79
    v_mfma_f32_32x32x16_bf16 v[32:47], v[172:175], v[148:151], 0
    v_exp_f32 v16, v16
    v_exp_f32 v17, v17
    v_exp_f32 v18, v18
    v_exp_f32 v19, v19
    v_exp_f32 v20, v20
    v_smfmac_f32_32x32x32_bf16 v[128:143], v[192:195], v[64:71], v208
    v_exp_f32 v21, v21
    v_exp_f32 v22, v22
    v_exp_f32 v23, v23
    v_exp_f32 v24, v24
    v_exp_f32 v25, v25
    v_smfmac_f32_32x32x32_bf16 v[128:143], v[196:199], v[72:79], v208
    v_exp_f32 v26, v26
    v_exp_f32 v27, v27
    v_exp_f32 v28, v28
    v_exp_f32 v29, v29
    v_exp_f32 v30, v30
    v_exp_f32 v31, v31
    s_add_u32 s48, s42, s45
    s_add_u32 s49, s43, s45
    buffer_load_dwordx4 v[168:171], v4, s[24:27], s48 offen sc1
    s_mov_b64 exec, s[46:47]
    buffer_load_dwordx4 v[192:195], v5, s[24:27], s49 offen sc1
    buffer_load_dwordx4 v[196:199], v5, s[24:27], s49 offen offset:512 sc1
    s_mov_b64 exec, -1
    s_add_u32 s45, s45, 1024
    s_and_b32 s45, s45, 0x3fff
    s_cmp_lg_u32 s28, 0
    s_cbranch_scc1 L_gu1_0
    s_mov_b32 s20, s12
    s_and_b32 s21, s13, 0xffff
    s_mov_b32 s22, s65
    s_lshl_b32 s33, s28, 10
    s_add_u32 m0, s33, 152576
    s_lshl_b32 s33, s60, 4
    buffer_load_dwordx4 v215, s[20:23], s33 offen lds
L_gu1_0:
    v_mfma_f32_32x32x16_bf16 v[48:63], v[172:175], v[152:155], 0
    v_exp_f32 v32, v32
    v_exp_f32 v33, v33
    v_exp_f32 v34, v34
    v_exp_f32 v35, v35
    v_exp_f32 v36, v36
    v_smfmac_f32_32x32x32_bf16 v[80:95], v[200:203], v[16:23], v208
    v_exp_f32 v37, v37
    v_exp_f32 v38, v38
    v_exp_f32 v39, v39
    v_exp_f32 v40, v40
    v_exp_f32 v41, v41
    v_smfmac_f32_32x32x32_bf16 v[80:95], v[204:207], v[24:31], v208
    v_exp_f32 v42, v42
    v_exp_f32 v43, v43
    v_exp_f32 v44, v44
    v_exp_f32 v45, v45
    v_exp_f32 v46, v46
    v_exp_f32 v47, v47
    v_mfma_f32_32x32x16_bf16 v[64:79], v[172:175], v[156:159], 0
    v_exp_f32 v48, v48
    v_exp_f32 v49, v49
    v_exp_f32 v50, v50
    v_exp_f32 v51, v51
    v_exp_f32 v52, v52
    v_smfmac_f32_32x32x32_bf16 v[96:111], v[200:203], v[32:39], v208
    v_exp_f32 v53, v53
    v_exp_f32 v54, v54
    v_exp_f32 v55, v55
    v_exp_f32 v56, v56
    v_exp_f32 v57, v57
    v_smfmac_f32_32x32x32_bf16 v[96:111], v[204:207], v[40:47], v208
    v_exp_f32 v58, v58
    v_exp_f32 v59, v59
    v_exp_f32 v60, v60
    v_exp_f32 v61, v61
    v_exp_f32 v62, v62
    v_exp_f32 v63, v63
    s_cmp_lg_u32 s28, 4
    s_cbranch_scc1 L_gu1_4
    s_mov_b32 s20, s12
    s_and_b32 s21, s13, 0xffff
    s_mov_b32 s22, s65
    s_lshl_b32 s33, s28, 10
    s_add_u32 m0, s33, 152576
    s_lshl_b32 s33, s60, 4
    buffer_load_dwordx4 v215, s[20:23], s33 offen lds
L_gu1_4:
    s_waitcnt vmcnt(10)
    v_mfma_f32_32x32x16_bf16 v[16:31], v[160:163], v[144:147], 0
    v_exp_f32 v64, v64
    v_exp_f32 v65, v65
    v_exp_f32 v66, v66
    v_exp_f32 v67, v67
    v_exp_f32 v68, v68
    v_smfmac_f32_32x32x32_bf16 v[112:127], v[200:203], v[48:55], v208
    v_exp_f32 v69, v69
    v_exp_f32 v70, v70
    v_exp_f32 v71, v71
    v_exp_f32 v72, v72
    v_exp_f32 v73, v73
    v_smfmac_f32_32x32x32_bf16 v[112:127], v[204:207], v[56:63], v208
    v_exp_f32 v74, v74
    v_exp_f32 v75, v75
    v_exp_f32 v76, v76
    v_exp_f32 v77, v77
    v_exp_f32 v78, v78
    v_exp_f32 v79, v79
    v_mfma_f32_32x32x16_bf16 v[32:47], v[160:163], v[148:151], 0
    v_exp_f32 v16, v16
    v_exp_f32 v17, v17
    v_exp_f32 v18, v18
    v_exp_f32 v19, v19
    v_exp_f32 v20, v20
    v_smfmac_f32_32x32x32_bf16 v[128:143], v[200:203], v[64:71], v208
    v_exp_f32 v21, v21
    v_exp_f32 v22, v22
    v_exp_f32 v23, v23
    v_exp_f32 v24, v24
    v_exp_f32 v25, v25
    v_smfmac_f32_32x32x32_bf16 v[128:143], v[204:207], v[72:79], v208
    v_exp_f32 v26, v26
    v_exp_f32 v27, v27
    v_exp_f32 v28, v28
    v_exp_f32 v29, v29
    v_exp_f32 v30, v30
    v_exp_f32 v31, v31
    s_add_u32 s48, s42, s45
    s_add_u32 s49, s43, s45
    buffer_load_dwordx4 v[172:175], v4, s[24:27], s48 offen sc1
    s_mov_b64 exec, s[46:47]
    buffer_load_dwordx4 v[200:203], v5, s[24:27], s49 offen sc1
    buffer_load_dwordx4 v[204:207], v5, s[24:27], s49 offen offset:512 sc1
    s_mov_b64 exec, -1
    s_add_u32 s45, s45, 1024
    s_and_b32 s45, s45, 0x3fff
    s_cmp_lg_u32 s28, 1
    s_cbranch_scc1 L_gu1_1
    s_mov_b32 s20, s12
    s_and_b32 s21, s13, 0xffff
    s_mov_b32 s22, s65
    s_lshl_b32 s33, s28, 10
    s_add_u32 m0, s33, 152576
    s_lshl_b32 s33, s60, 4
    buffer_load_dwordx4 v215, s[20:23], s33 offen lds
L_gu1_1:
    v_mfma_f32_32x32x16_bf16 v[48:63], v[160:163], v[152:155], 0
    v_exp_f32 v32, v32
    v_exp_f32 v33, v33
    v_exp_f32 v34, v34
    v_exp_f32 v35, v35
    v_exp_f32 v36, v36
    v_smfmac_f32_32x32x32_bf16 v[80:95], v[176:179], v[16:23], v208
    v_exp_f32 v37, v37
    v_exp_f32 v38, v38
    v_exp_f32 v39, v39
    v_exp_f32 v40, v40
    v_exp_f32 v41, v41
    v_smfmac_f32_32x32x32_bf16 v[80:95], v[180:183], v[24:31], v208
    v_exp_f32 v42, v42
    v_exp_f32 v43, v43
    v_exp_f32 v44, v44
    v_exp_f32 v45, v45
    v_exp_f32 v46, v46
    v_exp_f32 v47, v47
    v_mfma_f32_32x32x16_bf16 v[64:79], v[160:163], v[156:159], 0
    v_exp_f32 v48, v48
    v_exp_f32 v49, v49
    v_exp_f32 v50, v50
    v_exp_f32 v51, v51
    v_exp_f32 v52, v52
    v_smfmac_f32_32x32x32_bf16 v[96:111], v[176:179], v[32:39], v208
    v_exp_f32 v53, v53
    v_exp_f32 v54, v54
    v_exp_f32 v55, v55
    v_exp_f32 v56, v56
    v_exp_f32 v57, v57
    v_smfmac_f32_32x32x32_bf16 v[96:111], v[180:183], v[40:47], v208
    v_exp_f32 v58, v58
    v_exp_f32 v59, v59
    v_exp_f32 v60, v60
    v_exp_f32 v61, v61
    v_exp_f32 v62, v62
    v_exp_f32 v63, v63
    s_cmp_lg_u32 s28, 5
    s_cbranch_scc1 L_gu1_5
    s_mov_b32 s20, s12
    s_and_b32 s21, s13, 0xffff
    s_mov_b32 s22, s65
    s_lshl_b32 s33, s28, 10
    s_add_u32 m0, s33, 152576
    s_lshl_b32 s33, s60, 4
    buffer_load_dwordx4 v215, s[20:23], s33 offen lds
L_gu1_5:
    s_waitcnt vmcnt(8)
    v_mfma_f32_32x32x16_bf16 v[16:31], v[164:167], v[144:147], 0
    v_exp_f32 v64, v64
    v_exp_f32 v65, v65
    v_exp_f32 v66, v66
    v_exp_f32 v67, v67
    v_exp_f32 v68, v68
    v_smfmac_f32_32x32x32_bf16 v[112:127], v[176:179], v[48:55], v208
    v_exp_f32 v69, v69
    v_exp_f32 v70, v70
    v_exp_f32 v71, v71
    v_exp_f32 v72, v72
    v_exp_f32 v73, v73
    v_smfmac_f32_32x32x32_bf16 v[112:127], v[180:183], v[56:63], v208
    v_exp_f32 v74, v74
    v_exp_f32 v75, v75
    v_exp_f32 v76, v76
    v_exp_f32 v77, v77
    v_exp_f32 v78, v78
    v_exp_f32 v79, v79
    v_mfma_f32_32x32x16_bf16 v[32:47], v[164:167], v[148:151], 0
    v_exp_f32 v16, v16
    v_exp_f32 v17, v17
    v_exp_f32 v18, v18
    v_exp_f32 v19, v19
    v_exp_f32 v20, v20
    v_smfmac_f32_32x32x32_bf16 v[128:143], v[176:179], v[64:71], v208
    v_exp_f32 v21, v21
    v_exp_f32 v22, v22
    v_exp_f32 v23, v23
    v_exp_f32 v24, v24
    v_exp_f32 v25, v25
    v_smfmac_f32_32x32x32_bf16 v[128:143], v[180:183], v[72:79], v208
    v_exp_f32 v26, v26
    v_exp_f32 v27, v27
    v_exp_f32 v28, v28
    v_exp_f32 v29, v29
    v_exp_f32 v30, v30
    v_exp_f32 v31, v31
    s_add_u32 s48, s42, s45
    s_add_u32 s49, s43, s45
    buffer_load_dwordx4 v[160:163], v4, s[24:27], s48 offen sc1
    s_mov_b64 exec, s[46:47]
    buffer_load_dwordx4 v[176:179], v5, s[24:27], s49 offen sc1
    buffer_load_dwordx4 v[180:183], v5, s[24:27], s49 offen offset:512 sc1
    s_mov_b64 exec, -1
    s_add_u32 s45, s45, 1024
    s_and_b32 s45, s45, 0x3fff
    s_cmp_lg_u32 s28, 2
    s_cbranch_scc1 L_gu1_2
    s_mov_b32 s20, s12
    s_and_b32 s21, s13, 0xffff
    s_mov_b32 s22, s65
    s_lshl_b32 s33, s28, 10
    s_add_u32 m0, s33, 152576
    s_lshl_b32 s33, s60, 4
    buffer_load_dwordx4 v215, s[20:23], s33 offen lds
L_gu1_2:
    v_mfma_f32_32x32x16_bf16 v[48:63], v[164:167], v[152:155], 0
    v_exp_f32 v32, v32
    v_exp_f32 v33, v33
    v_exp_f32 v34, v34
    v_exp_f32 v35, v35
    v_exp_f32 v36, v36
    v_smfmac_f32_32x32x32_bf16 v[80:95], v[184:187], v[16:23], v208
    v_exp_f32 v37, v37
    v_exp_f32 v38, v38
    v_exp_f32 v39, v39
    v_exp_f32 v40, v40
    v_exp_f32 v41, v41
    v_smfmac_f32_32x32x32_bf16 v[80:95], v[188:191], v[24:31], v208
    v_exp_f32 v42, v42
    v_exp_f32 v43, v43
    v_exp_f32 v44, v44
    v_exp_f32 v45, v45
    v_exp_f32 v46, v46
    v_exp_f32 v47, v47
    v_mfma_f32_32x32x16_bf16 v[64:79], v[164:167], v[156:159], 0
    v_exp_f32 v48, v48
    v_exp_f32 v49, v49
    v_exp_f32 v50, v50
    v_exp_f32 v51, v51
    v_exp_f32 v52, v52
    v_smfmac_f32_32x32x32_bf16 v[96:111], v[184:187], v[32:39], v208
    v_exp_f32 v53, v53
    v_exp_f32 v54, v54
    v_exp_f32 v55, v55
    v_exp_f32 v56, v56
    v_exp_f32 v57, v57
    v_smfmac_f32_32x32x32_bf16 v[96:111], v[188:191], v[40:47], v208
    v_exp_f32 v58, v58
    v_exp_f32 v59, v59
    v_exp_f32 v60, v60
    v_exp_f32 v61, v61
    v_exp_f32 v62, v62
    v_exp_f32 v63, v63
    s_cmp_lg_u32 s28, 6
    s_cbranch_scc1 L_gu1_6
    s_mov_b32 s20, s12
    s_and_b32 s21, s13, 0xffff
    s_mov_b32 s22, s65
    s_lshl_b32 s33, s28, 10
    s_add_u32 m0, s33, 152576
    s_lshl_b32 s33, s60, 4
    buffer_load_dwordx4 v215, s[20:23], s33 offen lds
L_gu1_6:
    s_waitcnt vmcnt(6)
    v_mfma_f32_32x32x16_bf16 v[16:31], v[168:171], v[144:147], 0
    v_exp_f32 v64, v64
    v_exp_f32 v65, v65
    v_exp_f32 v66, v66
    v_exp_f32 v67, v67
    v_exp_f32 v68, v68
    v_smfmac_f32_32x32x32_bf16 v[112:127], v[184:187], v[48:55], v208
    v_exp_f32 v69, v69
    v_exp_f32 v70, v70
    v_exp_f32 v71, v71
    v_exp_f32 v72, v72
    v_exp_f32 v73, v73
    v_smfmac_f32_32x32x32_bf16 v[112:127], v[188:191], v[56:63], v208
    v_exp_f32 v74, v74
    v_exp_f32 v75, v75
    v_exp_f32 v76, v76
    v_exp_f32 v77, v77
    v_exp_f32 v78, v78
    v_exp_f32 v79, v79
    v_mfma_f32_32x32x16_bf16 v[32:47], v[168:171], v[148:151], 0
    v_exp_f32 v16, v16
    v_exp_f32 v17, v17
    v_exp_f32 v18, v18
    v_exp_f32 v19, v19
    v_exp_f32 v20, v20
    v_smfmac_f32_32x32x32_bf16 v[128:143], v[184:187], v[64:71], v208
    v_exp_f32 v21, v21
    v_exp_f32 v22, v22
    v_exp_f32 v23, v23
    v_exp_f32 v24, v24
    v_exp_f32 v25, v25
    v_smfmac_f32_32x32x32_bf16 v[128:143], v[188:191], v[72:79], v208
    v_exp_f32 v26, v26
    v_exp_f32 v27, v27
    v_exp_f32 v28, v28
    v_exp_f32 v29, v29
    v_exp_f32 v30, v30
    v_exp_f32 v31, v31
    s_add_u32 s48, s42, s45
    s_add_u32 s49, s43, s45
    buffer_load_dwordx4 v[164:167], v4, s[24:27], s48 offen sc1
    s_mov_b64 exec, s[46:47]
    buffer_load_dwordx4 v[184:187], v5, s[24:27], s49 offen sc1
    buffer_load_dwordx4 v[188:191], v5, s[24:27], s49 offen offset:512 sc1
    s_mov_b64 exec, -1
    s_add_u32 s45, s45, 1024
    s_and_b32 s45, s45, 0x3fff
    s_cmp_lg_u32 s28, 3
    s_cbranch_scc1 L_gu1_3
    s_mov_b32 s20, s12
    s_and_b32 s21, s13, 0xffff
    s_mov_b32 s22, s65
    s_lshl_b32 s33, s28, 10
    s_add_u32 m0, s33, 152576
    s_lshl_b32 s33, s60, 4
    buffer_load_dwordx4 v215, s[20:23], s33 offen lds
L_gu1_3:
    v_mfma_f32_32x32x16_bf16 v[48:63], v[168:171], v[152:155], 0
    v_exp_f32 v32, v32
    v_exp_f32 v33, v33
    v_exp_f32 v34, v34
    v_exp_f32 v35, v35
    v_exp_f32 v36, v36
    v_smfmac_f32_32x32x32_bf16 v[80:95], v[192:195], v[16:23], v208
    v_exp_f32 v37, v37
    v_exp_f32 v38, v38
    v_exp_f32 v39, v39
    v_exp_f32 v40, v40
    v_exp_f32 v41, v41
    v_smfmac_f32_32x32x32_bf16 v[80:95], v[196:199], v[24:31], v208
    v_exp_f32 v42, v42
    v_exp_f32 v43, v43
    v_exp_f32 v44, v44
    v_exp_f32 v45, v45
    v_exp_f32 v46, v46
    v_exp_f32 v47, v47
    v_mfma_f32_32x32x16_bf16 v[64:79], v[168:171], v[156:159], 0
    v_exp_f32 v48, v48
    v_exp_f32 v49, v49
    v_exp_f32 v50, v50
    v_exp_f32 v51, v51
    v_exp_f32 v52, v52
    v_smfmac_f32_32x32x32_bf16 v[96:111], v[192:195], v[32:39], v208
    v_exp_f32 v53, v53
    v_exp_f32 v54, v54
    v_exp_f32 v55, v55
    v_exp_f32 v56, v56
    v_exp_f32 v57, v57
    v_smfmac_f32_32x32x32_bf16 v[96:111], v[196:199], v[40:47], v208
    v_exp_f32 v58, v58
    v_exp_f32 v59, v59
    v_exp_f32 v60, v60
    v_exp_f32 v61, v61
    v_exp_f32 v62, v62
    v_exp_f32 v63, v63
    s_cmp_lg_u32 s28, 7
    s_cbranch_scc1 L_gu1_7
    s_mov_b32 s20, s12
    s_and_b32 s21, s13, 0xffff
    s_mov_b32 s22, s65
    s_lshl_b32 s33, s28, 10
    s_add_u32 m0, s33, 152576
    s_lshl_b32 s33, s60, 4
    buffer_load_dwordx4 v215, s[20:23], s33 offen lds
L_gu1_7:
    s_waitcnt vmcnt(6)
    v_mfma_f32_32x32x16_bf16 v[16:31], v[172:175], v[144:147], 0
    v_exp_f32 v64, v64
    v_exp_f32 v65, v65
    v_exp_f32 v66, v66
    v_exp_f32 v67, v67
    v_exp_f32 v68, v68
    v_smfmac_f32_32x32x32_bf16 v[112:127], v[192:195], v[48:55], v208
    v_exp_f32 v69, v69
    v_exp_f32 v70, v70
    v_exp_f32 v71, v71
    v_exp_f32 v72, v72
    v_exp_f32 v73, v73
    v_smfmac_f32_32x32x32_bf16 v[112:127], v[196:199], v[56:63], v208
    v_exp_f32 v74, v74
    v_exp_f32 v75, v75
    v_exp_f32 v76, v76
    v_exp_f32 v77, v77
    v_exp_f32 v78, v78
    v_exp_f32 v79, v79
    s_setprio 0
    v_mfma_f32_32x32x16_bf16 v[32:47], v[172:175], v[148:151], 0
    v_exp_f32 v16, v16
    v_exp_f32 v17, v17
    v_exp_f32 v18, v18
    v_exp_f32 v19, v19
    v_exp_f32 v20, v20
    v_smfmac_f32_32x32x32_bf16 v[128:143], v[192:195], v[64:71], v208
    v_exp_f32 v21, v21
    v_exp_f32 v22, v22
    v_exp_f32 v23, v23
    v_exp_f32 v24, v24
    v_exp_f32 v25, v25
    v_smfmac_f32_32x32x32_bf16 v[128:143], v[196:199], v[72:79], v208
    v_exp_f32 v26, v26
    v_exp_f32 v27, v27
    v_exp_f32 v28, v28
    v_exp_f32 v29, v29
    v_exp_f32 v30, v30
    v_exp_f32 v31, v31
    s_add_u32 s48, s42, s45
    s_add_u32 s49, s43, s45
    buffer_load_dwordx4 v[168:171], v4, s[24:27], s48 offen sc1
    s_mov_b64 exec, s[46:47]
    buffer_load_dwordx4 v[192:195], v5, s[24:27], s49 offen sc1
    buffer_load_dwordx4 v[196:199], v5, s[24:27], s49 offen offset:512 sc1
    s_mov_b64 exec, -1
    s_add_u32 s45, s45, 1024
    s_and_b32 s45, s45, 0x3fff
    v_mfma_f32_32x32x16_bf16 v[48:63], v[172:175], v[152:155], 0
    v_exp_f32 v32, v32
    v_exp_f32 v33, v33
    v_exp_f32 v34, v34
    v_exp_f32 v35, v35
    v_exp_f32 v36, v36
    v_smfmac_f32_32x32x32_bf16 v[80:95], v[200:203], v[16:23], v208
    v_exp_f32 v37, v37
    v_exp_f32 v38, v38
    v_exp_f32 v39, v39
    v_exp_f32 v40, v40
    v_exp_f32 v41, v41
    v_smfmac_f32_32x32x32_bf16 v[80:95], v[204:207], v[24:31], v208
    v_exp_f32 v42, v42
    v_exp_f32 v43, v43
    v_exp_f32 v44, v44
    v_exp_f32 v45, v45
    v_exp_f32 v46, v46
    v_exp_f32 v47, v47
    v_mfma_f32_32x32x16_bf16 v[64:79], v[172:175], v[156:159], 0
    v_exp_f32 v48, v48
    v_exp_f32 v49, v49
    v_exp_f32 v50, v50
    v_exp_f32 v51, v51
    v_exp_f32 v52, v52
    v_smfmac_f32_32x32x32_bf16 v[96:111], v[200:203], v[32:39], v208
    v_exp_f32 v53, v53
    v_exp_f32 v54, v54
    v_exp_f32 v55, v55
    v_exp_f32 v56, v56
    v_exp_f32 v57, v57
    v_smfmac_f32_32x32x32_bf16 v[96:111], v[204:207], v[40:47], v208
    v_exp_f32 v58, v58
    v_exp_f32 v59, v59
    v_exp_f32 v60, v60
    v_exp_f32 v61, v61
    v_exp_f32 v62, v62
    v_exp_f32 v63, v63
    s_waitcnt vmcnt(6)
    v_mfma_f32_32x32x16_bf16 v[16:31], v[160:163], v[144:147], 0
    v_exp_f32 v64, v64
    v_exp_f32 v65, v65
    v_exp_f32 v66, v66
    v_exp_f32 v67, v67
    v_exp_f32 v68, v68
    v_smfmac_f32_32x32x32_bf16 v[112:127], v[200:203], v[48:55], v208
    v_exp_f32 v69, v69
    v_exp_f32 v70, v70
    v_exp_f32 v71, v71
    v_exp_f32 v72, v72
    v_exp_f32 v73, v73
    v_smfmac_f32_32x32x32_bf16 v[112:127], v[204:207], v[56:63], v208
    v_exp_f32 v74, v74
    v_exp_f32 v75, v75
    v_exp_f32 v76, v76
    v_exp_f32 v77, v77
    v_exp_f32 v78, v78
    v_exp_f32 v79, v79
    v_mfma_f32_32x32x16_bf16 v[32:47], v[160:163], v[148:151], 0
    v_exp_f32 v16, v16
    v_exp_f32 v17, v17
    v_exp_f32 v18, v18
    v_exp_f32 v19, v19
    v_exp_f32 v20, v20
    v_smfmac_f32_32x32x32_bf16 v[128:143], v[200:203], v[64:71], v208
    v_exp_f32 v21, v21
    v_exp_f32 v22, v22
    v_exp_f32 v23, v23
    v_exp_f32 v24, v24
    v_exp_f32 v25, v25
    v_smfmac_f32_32x32x32_bf16 v[128:143], v[204:207], v[72:79], v208
    v_exp_f32 v26, v26
    v_exp_f32 v27, v27
    v_exp_f32 v28, v28
    v_exp_f32 v29, v29
    v_exp_f32 v30, v30
    v_exp_f32 v31, v31
    s_add_u32 s48, s42, s45
    s_add_u32 s49, s43, s45
    buffer_load_dwordx4 v[172:175], v4, s[24:27], s48 offen sc1
    s_mov_b64 exec, s[46:47]
    buffer_load_dwordx4 v[200:203], v5, s[24:27], s49 offen sc1
    buffer_load_dwordx4 v[204:207], v5, s[24:27], s49 offen offset:512 sc1
    s_mov_b64 exec, -1
    s_add_u32 s45, s45, 1024
    s_and_b32 s45, s45, 0x3fff
    v_mfma_f32_32x32x16_bf16 v[48:63], v[160:163], v[152:155], 0
    v_exp_f32 v32, v32
    v_exp_f32 v33, v33
    v_exp_f32 v34, v34
    v_exp_f32 v35, v35
    v_exp_f32 v36, v36
    v_smfmac_f32_32x32x32_bf16 v[80:95], v[176:179], v[16:23], v208
    v_exp_f32 v37, v37
    v_exp_f32 v38, v38
    v_exp_f32 v39, v39
    v_exp_f32 v40, v40
    v_exp_f32 v41, v41
    v_smfmac_f32_32x32x32_bf16 v[80:95], v[180:183], v[24:31], v208
    v_exp_f32 v42, v42
    v_exp_f32 v43, v43
    v_exp_f32 v44, v44
    v_exp_f32 v45, v45
    v_exp_f32 v46, v46
    v_exp_f32 v47, v47
    v_mfma_f32_32x32x16_bf16 v[64:79], v[160:163], v[156:159], 0
    v_exp_f32 v48, v48
    v_exp_f32 v49, v49
    v_exp_f32 v50, v50
    v_exp_f32 v51, v51
    v_exp_f32 v52, v52
    v_smfmac_f32_32x32x32_bf16 v[96:111], v[176:179], v[32:39], v208
    v_exp_f32 v53, v53
    v_exp_f32 v54, v54
    v_exp_f32 v55, v55
    v_exp_f32 v56, v56
    v_exp_f32 v57, v57
    v_smfmac_f32_32x32x32_bf16 v[96:111], v[180:183], v[40:47], v208
    v_exp_f32 v58, v58
    v_exp_f32 v59, v59
    v_exp_f32 v60, v60
    v_exp_f32 v61, v61
    v_exp_f32 v62, v62
    v_exp_f32 v63, v63
    s_waitcnt vmcnt(6)
    v_mfma_f32_32x32x16_bf16 v[16:31], v[164:167], v[144:147], 0
    v_exp_f32 v64, v64
    v_exp_f32 v65, v65
    v_exp_f32 v66, v66
    v_exp_f32 v67, v67
    v_exp_f32 v68, v68
    v_smfmac_f32_32x32x32_bf16 v[112:127], v[176:179], v[48:55], v208
    v_exp_f32 v69, v69
    v_exp_f32 v70, v70
    v_exp_f32 v71, v71
    v_exp_f32 v72, v72
    v_exp_f32 v73, v73
    v_smfmac_f32_32x32x32_bf16 v[112:127], v[180:183], v[56:63], v208
    v_exp_f32 v74, v74
    v_exp_f32 v75, v75
    v_exp_f32 v76, v76
    v_exp_f32 v77, v77
    v_exp_f32 v78, v78
    v_exp_f32 v79, v79
    v_mfma_f32_32x32x16_bf16 v[32:47], v[164:167], v[148:151], 0
    v_exp_f32 v16, v16
    v_exp_f32 v17, v17
    v_exp_f32 v18, v18
    v_exp_f32 v19, v19
    v_exp_f32 v20, v20
    v_smfmac_f32_32x32x32_bf16 v[128:143], v[176:179], v[64:71], v208
    v_exp_f32 v21, v21
    v_exp_f32 v22, v22
    v_exp_f32 v23, v23
    v_exp_f32 v24, v24
    v_exp_f32 v25, v25
    v_smfmac_f32_32x32x32_bf16 v[128:143], v[180:183], v[72:79], v208
    v_exp_f32 v26, v26
    v_exp_f32 v27, v27
    v_exp_f32 v28, v28
    v_exp_f32 v29, v29
    v_exp_f32 v30, v30
    v_exp_f32 v31, v31
    v_mfma_f32_32x32x16_bf16 v[48:63], v[164:167], v[152:155], 0
    v_exp_f32 v32, v32
    v_exp_f32 v33, v33
    v_exp_f32 v34, v34
    v_exp_f32 v35, v35
    v_exp_f32 v36, v36
    v_smfmac_f32_32x32x32_bf16 v[80:95], v[184:187], v[16:23], v208
    v_exp_f32 v37, v37
    v_exp_f32 v38, v38
    v_exp_f32 v39, v39
    v_exp_f32 v40, v40
    v_exp_f32 v41, v41
    v_smfmac_f32_32x32x32_bf16 v[80:95], v[188:191], v[24:31], v208
    v_exp_f32 v42, v42
    v_exp_f32 v43, v43
    v_exp_f32 v44, v44
    v_exp_f32 v45, v45
    v_exp_f32 v46, v46
    v_exp_f32 v47, v47
    v_mfma_f32_32x32x16_bf16 v[64:79], v[164:167], v[156:159], 0
    v_exp_f32 v48, v48
    v_exp_f32 v49, v49
    v_exp_f32 v50, v50
    v_exp_f32 v51, v51
    v_exp_f32 v52, v52
    v_smfmac_f32_32x32x32_bf16 v[96:111], v[184:187], v[32:39], v208
    v_exp_f32 v53, v53
    v_exp_f32 v54, v54
    v_exp_f32 v55, v55
    v_exp_f32 v56, v56
    v_exp_f32 v57, v57
    v_smfmac_f32_32x32x32_bf16 v[96:111], v[188:191], v[40:47], v208
    v_exp_f32 v58, v58
    v_exp_f32 v59, v59
    v_exp_f32 v60, v60
    v_exp_f32 v61, v61
    v_exp_f32 v62, v62
    v_exp_f32 v63, v63
    s_waitcnt vmcnt(3)
    v_mfma_f32_32x32x16_bf16 v[16:31], v[168:171], v[144:147], 0
    v_exp_f32 v64, v64
    v_exp_f32 v65, v65
    v_exp_f32 v66, v66
    v_exp_f32 v67, v67
    v_exp_f32 v68, v68
    v_smfmac_f32_32x32x32_bf16 v[112:127], v[184:187], v[48:55], v208
    v_exp_f32 v69, v69
    v_exp_f32 v70, v70
    v_exp_f32 v71, v71
    v_exp_f32 v72, v72
    v_exp_f32 v73, v73
    v_smfmac_f32_32x32x32_bf16 v[112:127], v[188:191], v[56:63], v208
    v_exp_f32 v74, v74
    v_exp_f32 v75, v75
    v_exp_f32 v76, v76
    v_exp_f32 v77, v77
    v_exp_f32 v78, v78
    v_exp_f32 v79, v79
    v_mfma_f32_32x32x16_bf16 v[32:47], v[168:171], v[148:151], 0
    v_exp_f32 v16, v16
    v_exp_f32 v17, v17
    v_exp_f32 v18, v18
    v_exp_f32 v19, v19
    v_exp_f32 v20, v20
    v_smfmac_f32_32x32x32_bf16 v[128:143], v[184:187], v[64:71], v208
    v_exp_f32 v21, v21
    v_exp_f32 v22, v22
    v_exp_f32 v23, v23
    v_exp_f32 v24, v24
    v_exp_f32 v25, v25
    v_smfmac_f32_32x32x32_bf16 v[128:143], v[188:191], v[72:79], v208
    v_exp_f32 v26, v26
    v_exp_f32 v27, v27
    v_exp_f32 v28, v28
    v_exp_f32 v29, v29
    v_exp_f32 v30, v30
    v_exp_f32 v31, v31
    v_mfma_f32_32x32x16_bf16 v[48:63], v[168:171], v[152:155], 0
    v_exp_f32 v32, v32
    v_exp_f32 v33, v33
    v_exp_f32 v34, v34
    v_exp_f32 v35, v35
    v_exp_f32 v36, v36
    v_smfmac_f32_32x32x32_bf16 v[80:95], v[192:195], v[16:23], v208
    v_exp_f32 v37, v37
    v_exp_f32 v38, v38
    v_exp_f32 v39, v39
    v_exp_f32 v40, v40
    v_exp_f32 v41, v41
    v_smfmac_f32_32x32x32_bf16 v[80:95], v[196:199], v[24:31], v208
    v_exp_f32 v42, v42
    v_exp_f32 v43, v43
    v_exp_f32 v44, v44
    v_exp_f32 v45, v45
    v_exp_f32 v46, v46
    v_exp_f32 v47, v47
    v_mfma_f32_32x32x16_bf16 v[64:79], v[168:171], v[156:159], 0
    v_exp_f32 v48, v48
    v_exp_f32 v49, v49
    v_exp_f32 v50, v50
    v_exp_f32 v51, v51
    v_exp_f32 v52, v52
    v_smfmac_f32_32x32x32_bf16 v[96:111], v[192:195], v[32:39], v208
    v_exp_f32 v53, v53
    v_exp_f32 v54, v54
    v_exp_f32 v55, v55
    v_exp_f32 v56, v56
    v_exp_f32 v57, v57
    v_smfmac_f32_32x32x32_bf16 v[96:111], v[196:199], v[40:47], v208
    v_exp_f32 v58, v58
    v_exp_f32 v59, v59
    v_exp_f32 v60, v60
    v_exp_f32 v61, v61
    v_exp_f32 v62, v62
    v_exp_f32 v63, v63
    s_waitcnt vmcnt(0)
    v_mfma_f32_32x32x16_bf16 v[16:31], v[172:175], v[144:147], 0
    v_exp_f32 v64, v64
    v_exp_f32 v65, v65
    v_exp_f32 v66, v66
    v_exp_f32 v67, v67
    v_exp_f32 v68, v68
    v_smfmac_f32_32x32x32_bf16 v[112:127], v[192:195], v[48:55], v208
    v_exp_f32 v69, v69
    v_exp_f32 v70, v70
    v_exp_f32 v71, v71
    v_exp_f32 v72, v72
    v_exp_f32 v73, v73
    v_smfmac_f32_32x32x32_bf16 v[112:127], v[196:199], v[56:63], v208
    v_exp_f32 v74, v74
    v_exp_f32 v75, v75
    v_exp_f32 v76, v76
    v_exp_f32 v77, v77
    v_exp_f32 v78, v78
    v_exp_f32 v79, v79
    v_mfma_f32_32x32x16_bf16 v[32:47], v[172:175], v[148:151], 0
    v_exp_f32 v16, v16
    v_exp_f32 v17, v17
    v_exp_f32 v18, v18
    v_exp_f32 v19, v19
    v_exp_f32 v20, v20
    v_smfmac_f32_32x32x32_bf16 v[128:143], v[192:195], v[64:71], v208
    v_exp_f32 v21, v21
    v_exp_f32 v22, v22
    v_exp_f32 v23, v23
    v_exp_f32 v24, v24
    v_exp_f32 v25, v25
    v_smfmac_f32_32x32x32_bf16 v[128:143], v[196:199], v[72:79], v208
    v_exp_f32 v26, v26
    v_exp_f32 v27, v27
    v_exp_f32 v28, v28
    v_exp_f32 v29, v29
    v_exp_f32 v30, v30
    v_exp_f32 v31, v31
    v_mfma_f32_32x32x16_bf16 v[48:63], v[172:175], v[152:155], 0
    v_exp_f32 v32, v32
    v_exp_f32 v33, v33
    v_exp_f32 v34, v34
    v_exp_f32 v35, v35
    v_exp_f32 v36, v36
    v_smfmac_f32_32x32x32_bf16 v[80:95], v[200:203], v[16:23], v208
    v_exp_f32 v37, v37
    v_exp_f32 v38, v38
    v_exp_f32 v39, v39
    v_exp_f32 v40, v40
    v_exp_f32 v41, v41
    v_smfmac_f32_32x32x32_bf16 v[80:95], v[204:207], v[24:31], v208
    v_exp_f32 v42, v42
    v_exp_f32 v43, v43
    v_exp_f32 v44, v44
    v_exp_f32 v45, v45
    v_exp_f32 v46, v46
    v_exp_f32 v47, v47
    v_mfma_f32_32x32x16_bf16 v[64:79], v[172:175], v[156:159], 0
    v_exp_f32 v48, v48
    v_exp_f32 v49, v49
    v_exp_f32 v50, v50
    v_exp_f32 v51, v51
    v_exp_f32 v52, v52
    v_smfmac_f32_32x32x32_bf16 v[96:111], v[200:203], v[32:39], v208
    v_exp_f32 v53, v53
    v_exp_f32 v54, v54
    v_exp_f32 v55, v55
    v_exp_f32 v56, v56
    v_exp_f32 v57, v57
    v_smfmac_f32_32x32x32_bf16 v[96:111], v[204:207], v[40:47], v208
    v_exp_f32 v58, v58
    v_exp_f32 v59, v59
    v_exp_f32 v60, v60
    v_exp_f32 v61, v61
    v_exp_f32 v62, v62
    v_exp_f32 v63, v63
    v_exp_f32 v64, v64
    v_exp_f32 v65, v65
    v_exp_f32 v66, v66
    v_exp_f32 v67, v67
    v_exp_f32 v68, v68
    v_smfmac_f32_32x32x32_bf16 v[112:127], v[200:203], v[48:55], v208
    v_exp_f32 v69, v69
    v_exp_f32 v70, v70
    v_exp_f32 v71, v71
    v_exp_f32 v72, v72
    v_exp_f32 v73, v73
    v_smfmac_f32_32x32x32_bf16 v[112:127], v[204:207], v[56:63], v208
    v_exp_f32 v74, v74
    v_exp_f32 v75, v75
    v_exp_f32 v76, v76
    v_exp_f32 v77, v77
    v_exp_f32 v78, v78
    v_exp_f32 v79, v79
    s_nop 1
    v_smfmac_f32_32x32x32_bf16 v[128:143], v[200:203], v[64:71], v208
    v_smfmac_f32_32x32x32_bf16 v[128:143], v[204:207], v[72:79], v208
L_combine:
    s_mul_i32 s53, s34, 27648
    v_lshlrev_b32 v8, 2, v2
    s_nop 7
    s_cmp_eq_u32 s35, 0
    s_cbranch_scc1 L_w0
    s_cmp_gt_u32 s35, 0
    s_cselect_b32 s54, 1, 0
    s_sub_u32 s54, s35, s54
    s_mul_i32 s54, s54, 2304
    s_add_u32 s54, s54, s53
    v_add_u32 v9, s54, v7
    v_add_u32 v10, s54, v8
    ds_write_b128 v9, v[80:83] offset:0
    ds_write_b128 v9, v[84:87] offset:1024
    ds_write_b32 v10, v88 offset:2048
    s_branch L_x0
L_w0:
    v_mov_b64 v[16:17], v[80:81]
    v_mov_b64 v[18:19], v[82:83]
    v_mov_b64 v[20:21], v[84:85]
    v_mov_b64 v[22:23], v[86:87]
    v_mov_b32 v24, v88
L_x0:
    s_cmp_eq_u32 s35, 1
    s_cbranch_scc1 L_w1
    s_cmp_gt_u32 s35, 1
    s_cselect_b32 s54, 1, 0
    s_sub_u32 s54, s35, s54
    s_mul_i32 s54, s54, 2304
    s_add_u32 s54, s54, s53
    v_add_u32 v9, s54, v7
    v_add_u32 v10, s54, v8
    ds_write_b128 v9, v[96:99] offset:6912
    ds_write_b128 v9, v[100:103] offset:7936
    ds_write_b32 v10, v104 offset:8960
    s_branch L_x1
L_w1:
    v_mov_b64 v[16:17], v[96:97]
    v_mov_b64 v[18:19], v[98:99]
    v_mov_b64 v[20:21], v[100:101]
    v_mov_b64 v[22:23], v[102:103]
    v_mov_b32 v24, v104
L_x1:
    s_cmp_eq_u32 s35, 2
    s_cbranch_scc1 L_w2
    s_cmp_gt_u32 s35, 2
    s_cselect_b32 s54, 1, 0
    s_sub_u32 s54, s35, s54
    s_mul_i32 s54, s54, 2304
    s_add_u32 s54, s54, s53
    v_add_u32 v9, s54, v7
    v_add_u32 v10, s54, v8
    ds_write_b128 v9, v[112:115] offset:13824
    ds_write_b128 v9, v[116:119] offset:14848
    ds_write_b32 v10, v120 offset:15872
    s_branch L_x2
L_w2:
    v_mov_b64 v[16:17], v[112:113]
    v_mov_b64 v[18:19], v[114:115]
    v_mov_b64 v[20:21], v[116:117]
    v_mov_b64 v[22:23], v[118:119]
    v_mov_b32 v24, v120
L_x2:
    s_cmp_eq_u32 s35, 3
    s_cbranch_scc1 L_w3
    s_cmp_gt_u32 s35, 3
    s_cselect_b32 s54, 1, 0
    s_sub_u32 s54, s35, s54
    s_mul_i32 s54, s54, 2304
    s_add_u32 s54, s54, s53
    v_add_u32 v9, s54, v7
    v_add_u32 v10, s54, v8
    ds_write_b128 v9, v[128:131] offset:20736
    ds_write_b128 v9, v[132:135] offset:21760
    ds_write_b32 v10, v136 offset:22784
    s_branch L_x3
L_w3:
    v_mov_b64 v[16:17], v[128:129]
    v_mov_b64 v[18:19], v[130:131]
    v_mov_b64 v[20:21], v[132:133]
    v_mov_b64 v[22:23], v[134:135]
    v_mov_b32 v24, v136
L_x3:
    s_mul_i32 s54, s35, 6912
    s_add_u32 s54, s54, s53
    v_add_u32 v9, s54, v7
    v_add_u32 v10, s54, v8
    s_waitcnt vmcnt(0) lgkmcnt(0)
    s_barrier
    ds_read_b128 v[32:35], v9 offset:0
    ds_read_b128 v[36:39], v9 offset:1024
    ds_read_b32 v40, v10 offset:2048
    ds_read_b128 v[44:47], v9 offset:2304
    ds_read_b128 v[48:51], v9 offset:3328
    ds_read_b32 v52, v10 offset:4352
    ds_read_b128 v[56:59], v9 offset:4608
    ds_read_b128 v[60:63], v9 offset:5632
    ds_read_b32 v64, v10 offset:6656
    s_lshl_b32 s33, s35, 10
    s_add_u32 s41, s41, s33
    s_add_u32 s41, s41, 0x800000
    s_waitcnt lgkmcnt(6)
    v_pk_add_f32 v[16:17], v[16:17], v[32:33]
    v_pk_add_f32 v[18:19], v[18:19], v[34:35]
    v_pk_add_f32 v[20:21], v[20:21], v[36:37]
    v_pk_add_f32 v[22:23], v[22:23], v[38:39]
    v_add_f32 v24, v24, v40
    s_waitcnt lgkmcnt(3)
    v_pk_add_f32 v[16:17], v[16:17], v[44:45]
    v_pk_add_f32 v[18:19], v[18:19], v[46:47]
    v_pk_add_f32 v[20:21], v[20:21], v[48:49]
    v_pk_add_f32 v[22:23], v[22:23], v[50:51]
    v_add_f32 v24, v24, v52
    s_waitcnt lgkmcnt(0)
    v_pk_add_f32 v[16:17], v[16:17], v[56:57]
    v_pk_add_f32 v[18:19], v[18:19], v[58:59]
    v_pk_add_f32 v[20:21], v[20:21], v[60:61]
    v_pk_add_f32 v[22:23], v[22:23], v[62:63]
    v_add_f32 v24, v24, v64
    v_rcp_f32 v24, v24
    s_nop 0
    v_pk_mul_f32 v[16:17], v[16:17], v[24:25] op_sel_hi:[1,0]
    v_pk_mul_f32 v[18:19], v[18:19], v[24:25] op_sel_hi:[1,0]
    v_pk_mul_f32 v[20:21], v[20:21], v[24:25] op_sel_hi:[1,0]
    v_pk_mul_f32 v[22:23], v[22:23], v[24:25] op_sel_hi:[1,0]
    v_cvt_pk_bf16_f32 v12, v16, v17
    v_cvt_pk_bf16_f32 v13, v18, v19
    v_cvt_pk_bf16_f32 v14, v20, v21
    v_cvt_pk_bf16_f32 v15, v22, v23
    buffer_store_dwordx4 v[12:15], v4, s[24:27], s41 offen sc1
    s_lshl_b32 s40, s35, 19
    s_lshl_b32 s33, s31, 11
    s_add_u32 s40, s40, s33
    s_lshl_b32 s33, s34, 10
    s_add_u32 s40, s40, s33
    s_add_u32 s40, s40, 0x800000
    s_mov_b32 s52, 0xff
    s_mov_b32 s53, 0
    s_barrier
    v_bfe_u32 v8, v2, 2, 2
    v_lshlrev_b32 v9, 10, v6
    v_lshl_add_u32 v9, v8, 7, v9
    v_bfe_u32 v8, v2, 3, 1
    v_lshl_add_u32 v9, v8, 6, v9
    v_and_b32 v8, 1, v2
    v_lshl_add_u32 v9, v8, 5, v9
    v_bfe_u32 v8, v2, 4, 1
    v_lshl_add_u32 v9, v8, 4, v9
    v_bfe_u32 v8, v2, 1, 1
    v_lshl_add_u32 v9, v8, 3, v9
    s_lshl_b32 s33, s35, 14
    s_add_u32 s33, s33, 65536
    v_add_u32 v9, s33, v9
    v_xor_b32 v10, 64, v9
    ds_read_b64_tr_b16 v[96:97], v9 offset:0
    ds_read_b64_tr_b16 v[98:99], v9 offset:512
    ds_read_b64_tr_b16 v[100:101], v10 offset:0
    ds_read_b64_tr_b16 v[102:103], v10 offset:512
    ds_read_b64_tr_b16 v[104:105], v9 offset:2048
    ds_read_b64_tr_b16 v[106:107], v9 offset:2560
    ds_read_b64_tr_b16 v[108:109], v10 offset:2048
    ds_read_b64_tr_b16 v[110:111], v10 offset:2560
    ds_read_b64_tr_b16 v[112:113], v9 offset:4096
    ds_read_b64_tr_b16 v[114:115], v9 offset:4608
    ds_read_b64_tr_b16 v[116:117], v10 offset:4096
    ds_read_b64_tr_b16 v[118:119], v10 offset:4608
    ds_read_b64_tr_b16 v[120:121], v9 offset:6144
    ds_read_b64_tr_b16 v[122:123], v9 offset:6656
    ds_read_b64_tr_b16 v[124:125], v10 offset:6144
    ds_read_b64_tr_b16 v[126:127], v10 offset:6656
    ds_read_b64_tr_b16 v[128:129], v9 offset:8192
    ds_read_b64_tr_b16 v[130:131], v9 offset:8704
    ds_read_b64_tr_b16 v[132:133], v10 offset:8192
    ds_read_b64_tr_b16 v[134:135], v10 offset:8704
    ds_read_b64_tr_b16 v[136:137], v9 offset:10240
    ds_read_b64_tr_b16 v[138:139], v9 offset:10752
    ds_read_b64_tr_b16 v[140:141], v10 offset:10240
    ds_read_b64_tr_b16 v[142:143], v10 offset:10752
    ds_read_b64_tr_b16 v[144:145], v9 offset:12288
    ds_read_b64_tr_b16 v[146:147], v9 offset:12800
    ds_read_b64_tr_b16 v[148:149], v10 offset:12288
    ds_read_b64_tr_b16 v[150:151], v10 offset:12800
    ds_read_b64_tr_b16 v[152:153], v9 offset:14336
    ds_read_b64_tr_b16 v[154:155], v9 offset:14848
    ds_read_b64_tr_b16 v[156:157], v10 offset:14336
    ds_read_b64_tr_b16 v[158:159], v10 offset:14848
    v_mov_b32 v14, 0x3f803f80
    s_mov_b32 s66, 0xffff0000
    v_dot2_f32_bf16 v15, v240, v14, 0
    v_dot2_f32_bf16 v15, v241, v14, v15
    v_dot2_f32_bf16 v15, v242, v14, v15
    v_dot2_f32_bf16 v15, v243, v14, v15
    v_lshlrev_b32 v160, 16, v216
    v_and_b32 v161, s66, v216
    v_lshlrev_b32 v162, 16, v217
    v_and_b32 v163, s66, v217
    v_lshlrev_b32 v164, 16, v218
    v_and_b32 v165, s66, v218
    v_lshlrev_b32 v166, 16, v219
    v_and_b32 v167, s66, v219
    v_add_u32 v8, 136192, v244
    v_lshrrev_b32 v11, 4, v2
    v_lshlrev_b32 v11, 7, v11
    v_bfe_u32 v12, v2, 2, 2
    v_lshl_add_u32 v11, v12, 4, v11
    v_bfe_u32 v12, v2, 1, 1
    v_lshl_add_u32 v11, v12, 13, v11
    v_and_b32 v12, 1, v2
    v_lshl_add_u32 v11, v12, 3, v11
    s_lshl_b32 s33, s28, 10
    s_add_u32 s33, s33, 144384
    v_add_u32 v11, s33, v11
    v_add_f32_dpp v15, v15, v15 row_ror:8 row_mask:0xf bank_mask:0xf
    ds_read_u16 v232, v8 offset:0
    ds_read_u16 v233, v8 offset:1024
    v_add_f32_dpp v15, v15, v15 row_ror:4 row_mask:0xf bank_mask:0xf
    ds_read_u16 v234, v8 offset:2048
    ds_read_u16 v235, v8 offset:3072
    v_add_f32_dpp v15, v15, v15 row_ror:2 row_mask:0xf bank_mask:0xf
    ds_read_u16 v236, v8 offset:4096
    ds_read_u16 v237, v8 offset:5120
    v_add_f32_dpp v15, v15, v15 row_ror:1 row_mask:0xf bank_mask:0xf
    ds_read_u16 v238, v8 offset:6144
    ds_read_u16 v239, v8 offset:7168
    ds_read_b64_tr_b16 v[224:225], v11 offset:0
    ds_read_b64_tr_b16 v[226:227], v11 offset:64
    ds_read_b64_tr_b16 v[228:229], v11 offset:512
    ds_read_b64_tr_b16 v[230:231], v11 offset:576
    v_readlane_b32 s50, v15, 0
    v_readlane_b32 s51, v15, 16
    v_readlane_b32 s54, v15, 32
    v_readlane_b32 s55, v15, 48
    v_mov_b32 v15, s50
    v_add_f32 v15, s51, v15
    v_add_f32 v15, s54, v15
    v_add_f32 v15, s55, v15
    v_mov_b64 v[48:49], 0
    v_mov_b64 v[50:51], 0
    v_mov_b64 v[52:53], 0
    v_mov_b64 v[54:55], 0
    v_mov_b64 v[56:57], 0
    v_mov_b64 v[58:59], 0
    v_mov_b64 v[60:61], 0
    v_mov_b64 v[62:63], 0
    v_mov_b64 v[64:65], 0
    v_mov_b64 v[66:67], 0
    v_mov_b64 v[68:69], 0
    v_mov_b64 v[70:71], 0
    v_mov_b64 v[72:73], 0
    v_mov_b64 v[74:75], 0
    v_mov_b64 v[76:77], 0
    v_mov_b64 v[78:79], 0
    s_waitcnt lgkmcnt(0)
    v_lshlrev_b32 v232, 16, v232
    v_lshlrev_b32 v233, 16, v233
    v_lshlrev_b32 v234, 16, v234
    v_lshlrev_b32 v235, 16, v235
    v_lshlrev_b32 v236, 16, v236
    v_lshlrev_b32 v237, 16, v237
    v_lshlrev_b32 v238, 16, v238
    v_lshlrev_b32 v239, 16, v239
    s_add_u32 s33, s40, 0
    buffer_load_dwordx4 v[16:19], v4, s[24:27], s33 offen sc1
    s_add_u32 s33, s40, 65536
    buffer_load_dwordx4 v[20:23], v4, s[24:27], s33 offen sc1
    s_add_u32 s33, s40, 131072
    buffer_load_dwordx4 v[24:27], v4, s[24:27], s33 offen sc1
    s_add_u32 s33, s40, 196608
    buffer_load_dwordx4 v[28:31], v4, s[24:27], s33 offen sc1
    s_add_u32 s33, s40, 262144
    buffer_load_dwordx4 v[32:35], v4, s[24:27], s33 offen sc1
    s_add_u32 s33, s40, 327680
    buffer_load_dwordx4 v[36:39], v4, s[24:27], s33 offen sc1
    s_add_u32 s33, s40, 393216
    buffer_load_dwordx4 v[40:43], v4, s[24:27], s33 offen sc1
    s_add_u32 s33, s40, 458752
    buffer_load_dwordx4 v[44:47], v4, s[24:27], s33 offen sc1
L_opoll:
    s_waitcnt vmcnt(0)
    s_bitcmp1_b32 s52, 0
    s_cbranch_scc0 L_oc0
    v_cmp_eq_u32 vcc, -1, v16
    s_cbranch_vccnz L_or0
L_om0:
    s_bitset0_b32 s52, 0
    v_mfma_f32_32x32x16_bf16 v[48:63], v[96:99], v[16:19], v[48:63]
    v_mfma_f32_32x32x16_bf16 v[64:79], v[100:103], v[16:19], v[64:79]
    s_branch L_oc0
L_or0:
    s_cmp_gt_u32 s53, 200000
    s_cbranch_scc1 L_om0
    s_add_u32 s33, s40, 0
    buffer_load_dwordx4 v[16:19], v4, s[24:27], s33 offen sc1
L_oc0:
    s_bitcmp1_b32 s52, 1
    s_cbranch_scc0 L_oc1
    v_cmp_eq_u32 vcc, -1, v20
    s_cbranch_vccnz L_or1
L_om1:
    s_bitset0_b32 s52, 1
    v_mfma_f32_32x32x16_bf16 v[48:63], v[104:107], v[20:23], v[48:63]
    v_mfma_f32_32x32x16_bf16 v[64:79], v[108:111], v[20:23], v[64:79]
    s_branch L_oc1
L_or1:
    s_cmp_gt_u32 s53, 200000
    s_cbranch_scc1 L_om1
    s_add_u32 s33, s40, 65536
    buffer_load_dwordx4 v[20:23], v4, s[24:27], s33 offen sc1
L_oc1:
    s_bitcmp1_b32 s52, 2
    s_cbranch_scc0 L_oc2
    v_cmp_eq_u32 vcc, -1, v24
    s_cbranch_vccnz L_or2
L_om2:
    s_bitset0_b32 s52, 2
    v_mfma_f32_32x32x16_bf16 v[48:63], v[112:115], v[24:27], v[48:63]
    v_mfma_f32_32x32x16_bf16 v[64:79], v[116:119], v[24:27], v[64:79]
    s_branch L_oc2
L_or2:
    s_cmp_gt_u32 s53, 200000
    s_cbranch_scc1 L_om2
    s_add_u32 s33, s40, 131072
    buffer_load_dwordx4 v[24:27], v4, s[24:27], s33 offen sc1
L_oc2:
    s_bitcmp1_b32 s52, 3
    s_cbranch_scc0 L_oc3
    v_cmp_eq_u32 vcc, -1, v28
    s_cbranch_vccnz L_or3
L_om3:
    s_bitset0_b32 s52, 3
    v_mfma_f32_32x32x16_bf16 v[48:63], v[120:123], v[28:31], v[48:63]
    v_mfma_f32_32x32x16_bf16 v[64:79], v[124:127], v[28:31], v[64:79]
    s_branch L_oc3
L_or3:
    s_cmp_gt_u32 s53, 200000
    s_cbranch_scc1 L_om3
    s_add_u32 s33, s40, 196608
    buffer_load_dwordx4 v[28:31], v4, s[24:27], s33 offen sc1
L_oc3:
    s_bitcmp1_b32 s52, 4
    s_cbranch_scc0 L_oc4
    v_cmp_eq_u32 vcc, -1, v32
    s_cbranch_vccnz L_or4
L_om4:
    s_bitset0_b32 s52, 4
    v_mfma_f32_32x32x16_bf16 v[48:63], v[128:131], v[32:35], v[48:63]
    v_mfma_f32_32x32x16_bf16 v[64:79], v[132:135], v[32:35], v[64:79]
    s_branch L_oc4
L_or4:
    s_cmp_gt_u32 s53, 200000
    s_cbranch_scc1 L_om4
    s_add_u32 s33, s40, 262144
    buffer_load_dwordx4 v[32:35], v4, s[24:27], s33 offen sc1
L_oc4:
    s_bitcmp1_b32 s52, 5
    s_cbranch_scc0 L_oc5
    v_cmp_eq_u32 vcc, -1, v36
    s_cbranch_vccnz L_or5
L_om5:
    s_bitset0_b32 s52, 5
    v_mfma_f32_32x32x16_bf16 v[48:63], v[136:139], v[36:39], v[48:63]
    v_mfma_f32_32x32x16_bf16 v[64:79], v[140:143], v[36:39], v[64:79]
    s_branch L_oc5
L_or5:
    s_cmp_gt_u32 s53, 200000
    s_cbranch_scc1 L_om5
    s_add_u32 s33, s40, 327680
    buffer_load_dwordx4 v[36:39], v4, s[24:27], s33 offen sc1
L_oc5:
    s_bitcmp1_b32 s52, 6
    s_cbranch_scc0 L_oc6
    v_cmp_eq_u32 vcc, -1, v40
    s_cbranch_vccnz L_or6
L_om6:
    s_bitset0_b32 s52, 6
    v_mfma_f32_32x32x16_bf16 v[48:63], v[144:147], v[40:43], v[48:63]
    v_mfma_f32_32x32x16_bf16 v[64:79], v[148:151], v[40:43], v[64:79]
    s_branch L_oc6
L_or6:
    s_cmp_gt_u32 s53, 200000
    s_cbranch_scc1 L_om6
    s_add_u32 s33, s40, 393216
    buffer_load_dwordx4 v[40:43], v4, s[24:27], s33 offen sc1
L_oc6:
    s_bitcmp1_b32 s52, 7
    s_cbranch_scc0 L_oc7
    v_cmp_eq_u32 vcc, -1, v44
    s_cbranch_vccnz L_or7
L_om7:
    s_bitset0_b32 s52, 7
    v_mfma_f32_32x32x16_bf16 v[48:63], v[152:155], v[44:47], v[48:63]
    v_mfma_f32_32x32x16_bf16 v[64:79], v[156:159], v[44:47], v[64:79]
    s_branch L_oc7
L_or7:
    s_cmp_gt_u32 s53, 200000
    s_cbranch_scc1 L_om7
    s_add_u32 s33, s40, 458752
    buffer_load_dwordx4 v[44:47], v4, s[24:27], s33 offen sc1
L_oc7:
    s_add_u32 s53, s53, 1
    s_cmp_lg_u32 s52, 0
    s_cbranch_scc1 L_opoll
    s_lshl_b32 s53, s28, 13
    v_add_u32 v9, s53, v7
    v_and_b32 v10, 7, v2
    s_lshl_b32 s33, s35, 3
    v_add_u32 v10, s33, v10
    v_bfe_u32 v11, v2, 4, 1
    v_lshl_add_u32 v10, v11, 5, v10
    v_lshlrev_b32 v10, 4, v10
    v_bfe_u32 v11, v2, 3, 1
    v_lshl_add_u32 v10, v11, 11, v10
    v_lshl_add_u32 v10, v6, 12, v10
    s_lshl_b32 s33, s34, 13
    v_add_u32 v10, s33, v10
    ds_write_b128 v9, v[48:51] offset:0
    ds_write_b128 v9, v[52:55] offset:1024
    ds_write_b128 v9, v[56:59] offset:2048
    ds_write_b128 v9, v[60:63] offset:3072
    ds_write_b128 v9, v[64:67] offset:4096
    ds_write_b128 v9, v[68:71] offset:5120
    ds_write_b128 v9, v[72:75] offset:6144
    ds_write_b128 v9, v[76:79] offset:7168
    s_lshl_b32 s40, s31, 13
    s_add_u32 s40, s40, 0xa00000
    s_lshl_b32 s33, s34, 9
    s_add_u32 s40, s40, s33
    s_lshl_b32 s33, s35, 7
    s_add_u32 s40, s40, s33
    s_lshl_b32 s33, s32, 10
    s_add_u32 s41, s40, s33
    s_waitcnt lgkmcnt(0)
    s_barrier
    ds_read_b128 v[16:19], v10 offset:0
    ds_read_b128 v[20:23], v10 offset:1024
    ds_read_b128 v[24:27], v10 offset:16384
    ds_read_b128 v[28:31], v10 offset:17408
    ds_read_b128 v[32:35], v10 offset:32768
    ds_read_b128 v[36:39], v10 offset:33792
    ds_read_b128 v[40:43], v10 offset:49152
    ds_read_b128 v[44:47], v10 offset:50176
    s_waitcnt lgkmcnt(6)
    v_pk_add_f32 v[160:161], v[160:161], v[16:17]
    v_pk_add_f32 v[162:163], v[162:163], v[18:19]
    v_pk_add_f32 v[164:165], v[164:165], v[20:21]
    v_pk_add_f32 v[166:167], v[166:167], v[22:23]
    s_waitcnt lgkmcnt(4)
    v_pk_add_f32 v[160:161], v[160:161], v[24:25]
    v_pk_add_f32 v[162:163], v[162:163], v[26:27]
    v_pk_add_f32 v[164:165], v[164:165], v[28:29]
    v_pk_add_f32 v[166:167], v[166:167], v[30:31]
    s_waitcnt lgkmcnt(2)
    v_pk_add_f32 v[160:161], v[160:161], v[32:33]
    v_pk_add_f32 v[162:163], v[162:163], v[34:35]
    v_pk_add_f32 v[164:165], v[164:165], v[36:37]
    v_pk_add_f32 v[166:167], v[166:167], v[38:39]
    s_waitcnt lgkmcnt(0)
    v_pk_add_f32 v[160:161], v[160:161], v[40:41]
    v_pk_add_f32 v[162:163], v[162:163], v[42:43]
    v_pk_add_f32 v[164:165], v[164:165], v[44:45]
    v_pk_add_f32 v[166:167], v[166:167], v[46:47]
    v_cvt_pk_bf16_f32 v48, v160, v161
    v_cvt_pk_bf16_f32 v49, v162, v163
    v_cvt_pk_bf16_f32 v50, v164, v165
    v_cvt_pk_bf16_f32 v51, v166, v167
    v_dot2_f32_bf16 v52, v48, v14, 0
    v_dot2_f32_bf16 v53, v48, v48, 0
    v_dot2_f32_bf16 v54, v48, v220, 0
    v_dot2_f32_bf16 v52, v49, v14, v52
    v_dot2_f32_bf16 v53, v49, v49, v53
    v_dot2_f32_bf16 v54, v49, v221, v54
    v_dot2_f32_bf16 v52, v50, v14, v52
    v_dot2_f32_bf16 v53, v50, v50, v53
    v_dot2_f32_bf16 v54, v50, v222, v54
    v_dot2_f32_bf16 v52, v51, v14, v52
    v_dot2_f32_bf16 v53, v51, v51, v53
    v_dot2_f32_bf16 v54, v51, v223, v54
    v_lshlrev_b32 v56, 16, v48
    v_and_b32 v57, s66, v48
    v_lshlrev_b32 v58, 16, v49
    v_and_b32 v59, s66, v49
    v_mov_b32 v55, 0
    v_add_f32_dpp v52, v52, v52 row_ror:8 row_mask:0xf bank_mask:0xf
    v_add_f32_dpp v53, v53, v53 row_ror:8 row_mask:0xf bank_mask:0xf
    v_add_f32_dpp v54, v54, v54 row_ror:8 row_mask:0xf bank_mask:0xf
    v_mov_b32 v80, v52
    v_mov_b32 v81, v53
    v_mov_b32 v82, v54
    v_permlane16_swap_b32 v52, v80
    v_permlane16_swap_b32 v53, v81
    v_permlane16_swap_b32 v54, v82
    v_add_f32 v52, v52, v80
    v_add_f32 v53, v53, v81
    v_add_f32 v54, v54, v82
    v_mov_b32 v80, v52
    v_mov_b32 v81, v53
    v_mov_b32 v82, v54
    v_permlane32_swap_b32 v52, v80
    v_permlane32_swap_b32 v53, v81
    v_permlane32_swap_b32 v54, v82
    v_add_f32 v52, v52, v80
    v_add_f32 v53, v53, v81
    v_add_f32 v54, v54, v82
    s_mov_b64 exec, 0xff
    buffer_store_dwordx4 v[52:55], v7, s[24:27], s41 offen sc1
    s_mov_b64 exec, -1
    v_lshlrev_b32 v60, 16, v50
    v_and_b32 v61, s66, v50
    v_lshlrev_b32 v62, 16, v51
    v_and_b32 v63, s66, v51
    v_and_b32 v9, 7, v2
    v_lshlrev_b32 v11, 4, v9
    v_lshl_add_u32 v11, v245, 6, v11
    s_mov_b32 s53, 0
    s_mov_b32 s48, 0x3b000000
    s_mov_b32 s49, 0x3727c5ac
    s_lshl_b32 s33, s31, 6
    s_lshl_b32 s54, s34, 5
    s_add_u32 s33, s33, s54
    s_lshl_b32 s54, s35, 3
    s_add_u32 s33, s33, s54
    s_sub_u32 s33, 2047, s33
    v_sub_u32 v28, s33, v9
    s_mov_b32 s56, s16
    s_and_b32 s57, s17, 0xffff
    s_mov_b32 s58, 0x200000
    s_mov_b32 s59, 0x00020000
    s_sleep 10
L_apoll:
    buffer_load_dwordx4 v[24:27], v11, s[24:27], s40 offen sc1
    s_add_u32 s53, s53, 1
    s_waitcnt vmcnt(0)
    v_cmp_ne_u32 vcc, 0, v27
    s_cmp_gt_u32 s53, 200000
    s_cbranch_scc1 L_adone
    s_cbranch_vccnz L_apoll
L_adone:
    v_add_f32_dpp v24, v24, v24 row_ror:8 row_mask:0xf bank_mask:0xf
    v_add_f32_dpp v25, v25, v25 row_ror:8 row_mask:0xf bank_mask:0xf
    v_add_f32_dpp v26, v26, v26 row_ror:8 row_mask:0xf bank_mask:0xf
    v_mov_b32 v80, v24
    v_mov_b32 v81, v25
    v_mov_b32 v82, v26
    v_permlane16_swap_b32 v24, v80
    v_permlane16_swap_b32 v25, v81
    v_permlane16_swap_b32 v26, v82
    v_add_f32 v24, v24, v80
    v_add_f32 v25, v25, v81
    v_add_f32 v26, v26, v82
    v_mov_b32 v80, v24
    v_mov_b32 v81, v25
    v_mov_b32 v82, v26
    v_permlane32_swap_b32 v24, v80
    v_permlane32_swap_b32 v25, v81
    v_permlane32_swap_b32 v26, v82
    v_add_f32 v24, v24, v80
    v_add_f32 v25, v25, v81
    v_add_f32 v26, v26, v82
    v_mul_f32 v24, s48, v24
    v_mul_f32 v25, s48, v25
    v_fma_f32 v25, -v24, v24, v25
    v_max_f32 v25, 0, v25
    v_cvt_pk_bf16_f32 v25, v24, v25
    v_lshlrev_b32 v24, 16, v25
    v_and_b32 v25, s66, v25
    v_add_f32 v25, s49, v25
    v_cvt_pk_bf16_f32 v25, v25, v25
    v_and_b32 v25, s66, v25
    v_sqrt_f32 v25, v25
    v_fma_f32 v26, -v24, v15, v26
    v_cvt_pk_bf16_f32 v25, v25, v25
    v_and_b32 v25, s66, v25
    v_rcp_f32 v25, v25
    s_lshl_b32 s33, s28, 2
    s_add_u32 s33, s33, 131072
    v_mul_f32 v26, v26, v25
    v_ashrrev_i32 v27, 31, v26
    v_cmp_o_f32 vcc, v26, v26
    v_or_b32 v27, 0x80000000, v27
    v_xor_b32 v27, v27, v26
    v_and_b32 v27, 0xfffff800, v27
    v_cndmask_b32 v27, 0, v27, vcc
    v_or_b32 v27, v27, v28
    v_mov_b32 v28, v27
    v_mul_f32 v30, v24, v25
    v_add_f32 v31, 1.0, v25
    v_max_u32_dpp v28, v28, v28 row_ror:4 row_mask:0xf bank_mask:0xf
    v_mov_b32 v9, s33
    v_mov_b32 v10, 131072
    v_max_u32_dpp v28, v28, v28 row_ror:2 row_mask:0xf bank_mask:0xf
    v_fma_f32 v64, v56, v31, -v30
    v_fma_f32 v65, v57, v31, -v30
    v_max_u32_dpp v28, v28, v28 row_ror:1 row_mask:0xf bank_mask:0xf
    v_fma_f32 v66, v58, v31, -v30
    ds_write_b32 v9, v28
    v_fma_f32 v67, v59, v31, -v30
    v_fma_f32 v68, v60, v31, -v30
    v_fma_f32 v69, v61, v31, -v30
    v_fma_f32 v70, v62, v31, -v30
    v_fma_f32 v71, v63, v31, -v30
    s_waitcnt lgkmcnt(0)
    s_barrier
    ds_read_b128 v[32:35], v10
    ds_read_b128 v[36:39], v10 offset:16
    v_cvt_pk_bf16_f32 v72, v64, v65
    v_cvt_pk_bf16_f32 v73, v66, v67
    v_cvt_pk_bf16_f32 v74, v68, v69
    v_cvt_pk_bf16_f32 v75, v70, v71
    s_lshl_b32 s33, s31, 10
    s_add_u32 s33, s33, s63
    s_add_u32 s33, s33, 0xab0000
    s_lshl_b32 s54, s31, 7
    s_add_u32 s54, s54, 0xac0000
    v_mov_b32 v9, 0
    v_mov_b32 v20, v27
    v_mov_b32 v21, v24
    v_mov_b32 v22, v25
    v_mov_b32 v23, v26
    s_waitcnt lgkmcnt(0)
    v_max3_u32 v32, v32, v33, v34
    v_max3_u32 v36, v36, v37, v38
    v_max3_u32 v32, v32, v35, v39
    v_max_u32 v32, v32, v36
    v_cmp_eq_u32 vcc, v32, v27
    s_mov_b64 s[36:37], vcc
    s_cbranch_vccz L_nokey
    s_mov_b64 exec, s[36:37]
    s_cmp_lg_u32 s32, 0
    s_cbranch_scc1 L_nokey2
    buffer_store_dwordx4 v[20:23], v9, s[24:27], s54 offen sc1
L_nokey2:
    buffer_store_dwordx4 v[48:51], v245, s[24:27], s33 offen sc1
L_nokey:
    s_not_b64 exec, s[36:37]
    buffer_store_dwordx4 v[72:75], v214, s[56:59], s64 offen
    s_mov_b64 exec, -1
    s_cmp_lg_u32 s28, 0
    s_cbranch_scc1 L_bwait
    v_lshlrev_b32 v9, 7, v3
    s_mov_b32 s40, 0xac0000
    s_mov_b32 s53, 0
    s_sleep 22
L_bpoll:
    buffer_load_dwordx4 v[24:27], v9, s[24:27], s40 offen sc1
    s_add_u32 s53, s53, 1
    s_waitcnt vmcnt(0)
    v_cmp_eq_u32 vcc, -1, v24
    s_cmp_gt_u32 s53, 200000
    s_cbranch_scc1 L_bdone
    s_cbranch_vccz L_bdone
    s_sleep 2
    s_branch L_bpoll
L_bdone:
    v_mov_b32 v28, v24
    s_nop 1
    v_max_u32_dpp v28, v28, v28 row_shr:1 row_mask:0xf bank_mask:0xf
    s_nop 1
    v_max_u32_dpp v28, v28, v28 row_shr:2 row_mask:0xf bank_mask:0xf
    s_nop 1
    v_max_u32_dpp v28, v28, v28 row_shr:4 row_mask:0xf bank_mask:0xf
    s_nop 1
    v_max_u32_dpp v28, v28, v28 row_shr:8 row_mask:0xf bank_mask:0xf
    s_nop 1
    v_max_u32_dpp v28, v28, v28 row_bcast:15 row_mask:0xa bank_mask:0xf
    s_nop 1
    v_readlane_b32 s69, v28, 31
    s_nop 3
    s_and_b32 s50, s69, 0x7ff
    s_sub_u32 s50, 2047, s50
    s_lshr_b32 s51, s50, 6
    s_lshl_b32 s40, s51, 10
    s_add_u32 s40, s40, 0xab0000
    s_mov_b32 s53, 0
    v_cmp_eq_u32 s[38:39], s69, v24
    v_readlane_b32 s54, v25, s51
    v_readlane_b32 s55, v26, s51
    v_mov_b32 v10, 131136
    v_add_u32 v11, 132096, v7
L_rpoll:
    buffer_load_dwordx4 v[32:35], v7, s[24:27], s40 offen sc1
    s_add_u32 s53, s53, 1
    s_waitcnt vmcnt(0)
    v_cmp_eq_u32 vcc, -1, v32
    s_cmp_gt_u32 s53, 200000
    s_cbranch_scc1 L_rdone
    s_cbranch_vccnz L_rpoll
L_rdone:
    ds_write_b128 v11, v[32:35]
    v_lshlrev_b32 v36, 16, v32
    v_and_b32 v37, s66, v32
    v_lshlrev_b32 v38, 16, v33
    v_and_b32 v39, s66, v33
    v_lshlrev_b32 v40, 16, v34
    v_and_b32 v41, s66, v34
    v_lshlrev_b32 v42, 16, v35
    v_and_b32 v43, s66, v35
    v_subrev_f32 v36, s54, v36
    v_subrev_f32 v37, s54, v37
    v_subrev_f32 v38, s54, v38
    v_subrev_f32 v39, s54, v39
    v_subrev_f32 v40, s54, v40
    v_subrev_f32 v41, s54, v41
    v_subrev_f32 v42, s54, v42
    v_subrev_f32 v43, s54, v43
    v_mul_f32 v36, s55, v36
    v_mul_f32 v37, s55, v37
    v_mul_f32 v38, s55, v38
    v_mul_f32 v39, s55, v39
    v_mul_f32 v40, s55, v40
    v_mul_f32 v41, s55, v41
    v_mul_f32 v42, s55, v42
    v_mul_f32 v43, s55, v43
    v_cvt_pk_bf16_f32 v44, v36, v37
    v_cvt_pk_bf16_f32 v45, v38, v39
    v_cvt_pk_bf16_f32 v46, v40, v41
    v_cvt_pk_bf16_f32 v47, v42, v43
    ds_write_b128 v11, v[44:47] offset:2048
    s_mov_b64 exec, s[38:39]
    ds_write_b128 v10, v[24:27]
    s_mov_b64 exec, -1
    s_waitcnt lgkmcnt(0)
L_bwait:
    v_lshrrev_b32 v12, 4, v2
    v_lshlrev_b32 v12, 4, v12
    s_lshl_b32 s33, s28, 7
    s_add_u32 s33, s33, 134144
    v_add_u32 v12, s33, v12
    v_mov_b32 v10, 131136
    v_add_u32 v11, 132096, v244
    s_barrier
    ds_read_b128 v[32:35], v12
    ds_read_b128 v[36:39], v12 offset:64
    ds_read_b128 v[24:27], v10
    ds_read_u16 v29, v11
    ds_read_u16 v31, v11 offset:2048
    v_lshrrev_b32 v20, 4, v2
    v_lshlrev_b32 v20, 4, v20
    s_lshl_b32 s33, s28, 6
    s_add_u32 s33, s33, 135168
    v_add_u32 v20, s33, v20
    v_and_b32 v21, 7, v2
    v_lshlrev_b32 v21, 2, v21
    v_add_u32 v21, 135168, v21
    s_waitcnt lgkmcnt(3)
    v_mfma_f32_16x16x32_bf16 v[96:99], v[224:227], v[32:35], 0
    v_mfma_f32_16x16x32_bf16 v[96:99], v[228:231], v[36:39], v[96:99]
    s_waitcnt lgkmcnt(0)
    v_readfirstlane_b32 s69, v24
    v_lshlrev_b32 v29, 16, v29
    v_lshlrev_b32 v31, 16, v31
    v_mov_b32 v19, v27
    s_and_b32 s50, s69, 0x7ff
    s_sub_u32 s50, 2047, s50
    s_lshr_b32 s51, s50, 6
    ds_write_b128 v20, v[96:99]
    s_cmp_eq_u32 s51, s31
    s_cbranch_scc1 L_winner
    s_cmp_eq_u64 s[36:37], 0
    s_cbranch_scc1 L_winner
    s_mov_b64 exec, s[36:37]
    buffer_store_dwordx4 v[72:75], v214, s[56:59], s64 offen
    s_mov_b64 exec, -1
L_winner:
    s_cmp_eq_u32 s65, 0
    s_cbranch_scc1 L_fin
    s_waitcnt lgkmcnt(0)
    s_barrier
    ds_read2_b32 v[32:33], v21 offset0:0 offset1:8
    ds_read2_b32 v[34:35], v21 offset0:16 offset1:24
    ds_read2_b32 v[36:37], v21 offset0:32 offset1:40
    ds_read2_b32 v[38:39], v21 offset0:48 offset1:56
    ds_read2_b32 v[40:41], v21 offset0:64 offset1:72
    ds_read2_b32 v[42:43], v21 offset0:80 offset1:88
    ds_read2_b32 v[44:45], v21 offset0:96 offset1:104
    ds_read2_b32 v[46:47], v21 offset0:112 offset1:120
    v_lshrrev_b32 v20, 5, v0
    v_mul_u32_u24 v20, 28672, v20
    v_lshl_add_u32 v20, v3, 2, v20
    s_lshl_b32 s33, s60, 7
    s_add_u32 s33, s33, 0xa40000
    s_mov_b32 s12, 0x11111111
    s_mov_b32 s13, 0x11111111
    s_waitcnt lgkmcnt(4)
    v_pk_add_f32 v[32:33], v[32:33], v[34:35]
    v_pk_add_f32 v[36:37], v[36:37], v[38:39]
    s_waitcnt lgkmcnt(0)
    v_pk_add_f32 v[40:41], v[40:41], v[42:43]
    v_pk_add_f32 v[44:45], v[44:45], v[46:47]
    v_pk_add_f32 v[32:33], v[32:33], v[36:37]
    v_pk_add_f32 v[40:41], v[40:41], v[44:45]
    v_pk_add_f32 v[32:33], v[32:33], v[40:41]
    v_mov_b32 v24, v32
    v_mov_b32 v36, v33
    v_cvt_pk_bf16_f32 v24, v24, v24
    v_and_b32 v24, 0xffff0000, v24
    v_cvt_pk_bf16_f32 v36, v36, v36
    v_and_b32 v36, 0xffff0000, v36
    v_mul_f32 v25, 0xbfb8aa3b, v24
    v_exp_f32 v25, v25
    s_nop 0
    v_add_f32 v25, 1.0, v25
    v_rcp_f32 v25, v25
    s_nop 0
    v_mul_f32 v24, v24, v25
    v_cvt_pk_bf16_f32 v24, v24, v24
    v_and_b32 v24, 0xffff0000, v24
    v_mul_f32 v24, v24, v36
    v_cvt_pk_bf16_f32 v24, v24, v24
    v_and_b32 v24, 0xffff0000, v24
    s_nop 0
    v_readlane_b32 s4, v24, 0
    v_readlane_b32 s5, v24, 1
    v_readlane_b32 s6, v24, 2
    v_readlane_b32 s7, v24, 3
    v_readlane_b32 s8, v24, 4
    v_readlane_b32 s9, v24, 5
    v_readlane_b32 s10, v24, 6
    v_readlane_b32 s11, v24, 7
    v_mul_f32 v24, s4, v232
    v_fmac_f32 v24, s5, v233
    v_fmac_f32 v24, s6, v234
    v_fmac_f32 v24, s7, v235
    v_fmac_f32 v24, s8, v236
    v_fmac_f32 v24, s9, v237
    v_fmac_f32 v24, s10, v238
    v_fmac_f32 v24, s11, v239
    v_cmp_ne_u32 vcc, -1, v24
    v_mov_b32 v27, 0x7fc00000
    s_nop 0
    v_cndmask_b32 v24, v27, v24, vcc
    s_nop 1
    v_mov_b32_dpp v25, v24 quad_perm:[1,1,1,1] row_mask:0xf bank_mask:0xf
    v_mov_b32_dpp v26, v24 quad_perm:[2,2,2,2] row_mask:0xf bank_mask:0xf
    v_mov_b32_dpp v27, v24 quad_perm:[3,3,3,3] row_mask:0xf bank_mask:0xf
    s_mov_b64 exec, s[12:13]
    buffer_store_dwordx4 v[24:27], v20, s[24:27], s33 offen sc1
    s_mov_b64 exec, -1
    s_cmp_ge_u32 s2, 16
    s_cbranch_scc1 L_fin
    v_lshlrev_b32 v9, 4, v0
    v_mov_b32 v10, 0x7fffffff
    v_cmp_gt_u32 vcc, 256, v0
    s_mul_i32 s40, s2, 28672
    s_add_u32 s40, s40, 0xa40000
    v_cndmask_b32 v10, v10, v9, vcc
    s_add_u32 s41, s40, 8192
    s_add_u32 s42, s40, 16384
    s_add_u32 s43, s40, 24576
    s_mov_b32 s53, 0
    v_cvt_pk_bf16_f32 v19, v19, v19
    v_and_b32 v19, 0xffff0000, v19
    v_mul_f32 v19, 0xbfb8aa3b, v19
    v_exp_f32 v19, v19
    s_nop 0
    v_add_f32 v19, 1.0, v19
    v_rcp_f32 v19, v19
    s_nop 0
    v_cvt_pk_bf16_f32 v19, v19, v19
    v_and_b32 v19, 0xffff0000, v19
    s_sleep 8
L_cpoll:
    buffer_load_dwordx4 v[32:35], v9, s[24:27], s40 offen sc1
    buffer_load_dwordx4 v[36:39], v9, s[24:27], s41 offen sc1
    buffer_load_dwordx4 v[40:43], v9, s[24:27], s42 offen sc1
    buffer_load_dwordx4 v[44:47], v10, s[24:27], s43 offen sc1
    s_add_u32 s53, s53, 1
    s_waitcnt vmcnt(0)
    v_max3_u32 v24, v32, v36, v40
    v_max_u32 v24, v24, v44
    v_cmp_eq_u32 vcc, -1, v24
    s_cmp_gt_u32 s53, 200000
    s_cbranch_scc1 L_cdone
    s_cbranch_vccnz L_cpoll
L_cdone:
    v_pk_add_f32 v[32:33], v[32:33], v[36:37]
    v_pk_add_f32 v[34:35], v[34:35], v[38:39]
    v_pk_add_f32 v[40:41], v[40:41], v[44:45]
    v_pk_add_f32 v[42:43], v[42:43], v[46:47]
    v_pk_add_f32 v[24:25], v[32:33], v[40:41]
    v_pk_add_f32 v[26:27], v[34:35], v[42:43]
    s_lshl_b32 s33, s28, 2
    s_add_u32 s33, s33, 133120
    v_permlane32_swap_b32 v24, v26
    v_permlane32_swap_b32 v25, v27
    v_lshrrev_b32 v20, 4, v2
    v_pk_add_f32 v[24:25], v[24:25], v[26:27]
    v_and_b32 v21, 7, v2
    v_lshlrev_b32 v20, 5, v20
    v_permlane16_swap_b32 v24, v25
    v_lshl_add_u32 v20, v21, 7, v20
    v_add_u32 v20, s33, v20
    v_add_f32 v24, v24, v25
    v_lshlrev_b32 v22, 5, v3
    v_add_u32 v22, 133120, v22
    v_add_f32_dpp v24, v24, v24 row_ror:8 row_mask:0xf bank_mask:0xf
    s_lshr_b32 s33, s2, 1
    s_nop 0
    ds_write_b32 v20, v24
    s_waitcnt lgkmcnt(0)
    s_barrier
    s_cmp_lg_u32 s28, s33
    s_cbranch_scc1 L_fin
    ds_read_b128 v[24:27], v22
    ds_read_b128 v[32:35], v22 offset:16
    s_and_b32 s33, s2, 1
    s_lshl_b32 s33, s33, 5
    s_waitcnt lgkmcnt(0)
    v_pk_add_f32 v[24:25], v[24:25], v[26:27]
    v_pk_add_f32 v[32:33], v[32:33], v[34:35]
    v_pk_add_f32 v[24:25], v[24:25], v[32:33]
    v_add_f32 v24, v24, v25
    v_cvt_pk_bf16_f32 v24, v24, v24
    v_and_b32 v24, 0xffff0000, v24
    v_mul_f32 v24, v24, v19
    v_cvt_pk_bf16_f32 v24, v24, v24
    v_and_b32 v24, 0xffff0000, v24
    v_add_f32 v24, v24, v31
    v_cvt_pk_bf16_f32 v24, v24, v24
    v_and_b32 v24, 0xffff0000, v24
    v_add_f32 v24, v24, v29
    v_cvt_pk_bf16_f32 v24, v24, v24
    s_lshl_b32 s40, s50, 10
    s_mov_b32 s4, -1
    s_mov_b32 s5, 0
    s_lshl_b64 exec, s[4:5], s33
    buffer_store_short v24, v244, s[56:59], s40 offen
L_fin:
L_end:
    s_endpgm
L_slow:
    s_mov_b32 s20, s6
    s_and_b32 s21, s7, 0xffff
    s_mov_b32 s22, 0x80000
    s_add_u32 m0, s62, 0
    s_add_u32 s33, s61, 0
    buffer_load_dwordx4 v213, s[20:23], s33 offen lds
    s_mov_b32 s20, s6
    s_and_b32 s21, s7, 0xffff
    s_mov_b32 s22, 0x80000
    s_add_u32 m0, s62, 1024
    s_add_u32 s33, s61, 8192
    buffer_load_dwordx4 v213, s[20:23], s33 offen lds
    s_mov_b32 s20, s6
    s_and_b32 s21, s7, 0xffff
    s_mov_b32 s22, 0x80000
    s_add_u32 m0, s62, 2048
    s_add_u32 s33, s61, 16384
    buffer_load_dwordx4 v213, s[20:23], s33 offen lds
    s_mov_b32 s20, s6
    s_and_b32 s21, s7, 0xffff
    s_mov_b32 s22, 0x80000
    s_add_u32 m0, s62, 3072
    s_add_u32 s33, s61, 24576
    buffer_load_dwordx4 v213, s[20:23], s33 offen lds
    s_mov_b32 s20, s6
    s_and_b32 s21, s7, 0xffff
    s_mov_b32 s22, 0x80000
    s_add_u32 m0, s62, 4096
    s_add_u32 s33, s61, 32768
    buffer_load_dwordx4 v213, s[20:23], s33 offen lds
    s_mov_b32 s20, s6
    s_and_b32 s21, s7, 0xffff
    s_mov_b32 s22, 0x80000
    s_add_u32 m0, s62, 5120
    s_add_u32 s33, s61, 40960
    buffer_load_dwordx4 v213, s[20:23], s33 offen lds
    s_mov_b32 s20, s6
    s_and_b32 s21, s7, 0xffff
    s_mov_b32 s22, 0x80000
    s_add_u32 m0, s62, 6144
    s_add_u32 s33, s61, 49152
    buffer_load_dwordx4 v213, s[20:23], s33 offen lds
    s_mov_b32 s20, s6
    s_and_b32 s21, s7, 0xffff
    s_mov_b32 s22, 0x80000
    s_add_u32 m0, s62, 7168
    s_add_u32 s33, s61, 57344
    buffer_load_dwordx4 v213, s[20:23], s33 offen lds
    s_mov_b32 s20, s4
    s_and_b32 s21, s5, 0xffff
    s_mov_b32 s22, 0x200000
    buffer_load_dwordx4 v[216:219], v214, s[20:23], s64 offen
    s_mov_b32 s20, s8
    s_and_b32 s21, s9, 0xffff
    s_mov_b32 s22, 1024
    buffer_load_dwordx4 v[220:223], v245, s[20:23], s63 offen
    s_mov_b32 s20, s8
    s_and_b32 s21, s9, 0xffff
    s_mov_b32 s22, 1024
    buffer_load_dwordx4 v[240:243], v7, s[20:23], 0 offen
    s_mov_b32 s20, s14
    s_and_b32 s21, s15, 0xffff
    s_mov_b32 s22, s65
    s_lshl_b32 s33, s28, 10
    s_add_u32 m0, s33, 136192
    s_lshl_b32 s50, s60, 13
    s_add_u32 s33, s33, s50
    buffer_load_dwordx4 v7, s[20:23], s33 offen lds
    s_mov_b32 s20, s10
    s_and_b32 s21, s11, 0xffff
    s_mov_b32 s22, s65
    s_lshl_b32 s33, s28, 10
    s_add_u32 m0, s33, 144384
    s_lshl_b32 s33, s60, 4
    buffer_load_dwordx4 v215, s[20:23], s33 offen lds
    s_mov_b32 s20, s12
    s_and_b32 s21, s13, 0xffff
    s_mov_b32 s22, s65
    s_lshl_b32 s33, s28, 10
    s_add_u32 m0, s33, 152576
    s_lshl_b32 s33, s60, 4
    buffer_load_dwordx4 v215, s[20:23], s33 offen lds
    s_waitcnt vmcnt(0)
    s_mov_b32 s55, s42
    s_mov_b32 s52, 16
    v_mov_b32 v209, 0xff800000
    v_mov_b32 v210, 0xff800000
    v_mov_b32 v211, 0xff800000
    v_mov_b32 v212, 0xff800000
L_s1:
    buffer_load_dwordx4 v[160:163], v4, s[24:27], s55 offen sc1
    s_add_u32 s55, s55, 1024
    s_waitcnt vmcnt(0)
    v_mfma_f32_32x32x16_bf16 v[16:31], v[160:163], v[144:147], 0
    v_mfma_f32_32x32x16_bf16 v[32:47], v[160:163], v[148:151], 0
    v_mfma_f32_32x32x16_bf16 v[48:63], v[160:163], v[152:155], 0
    v_mfma_f32_32x32x16_bf16 v[64:79], v[160:163], v[156:159], 0
    s_nop 15
    v_max3_f32 v209, v16, v17, v209
    v_max3_f32 v209, v18, v19, v209
    v_max3_f32 v209, v20, v21, v209
    v_max3_f32 v209, v22, v23, v209
    v_max3_f32 v209, v24, v25, v209
    v_max3_f32 v209, v26, v27, v209
    v_max3_f32 v209, v28, v29, v209
    v_max3_f32 v209, v30, v31, v209
    v_max3_f32 v210, v32, v33, v210
    v_max3_f32 v210, v34, v35, v210
    v_max3_f32 v210, v36, v37, v210
    v_max3_f32 v210, v38, v39, v210
    v_max3_f32 v210, v40, v41, v210
    v_max3_f32 v210, v42, v43, v210
    v_max3_f32 v210, v44, v45, v210
    v_max3_f32 v210, v46, v47, v210
    v_max3_f32 v211, v48, v49, v211
    v_max3_f32 v211, v50, v51, v211
    v_max3_f32 v211, v52, v53, v211
    v_max3_f32 v211, v54, v55, v211
    v_max3_f32 v211, v56, v57, v211
    v_max3_f32 v211, v58, v59, v211
    v_max3_f32 v211, v60, v61, v211
    v_max3_f32 v211, v62, v63, v211
    v_max3_f32 v212, v64, v65, v212
    v_max3_f32 v212, v66, v67, v212
    v_max3_f32 v212, v68, v69, v212
    v_max3_f32 v212, v70, v71, v212
    v_max3_f32 v212, v72, v73, v212
    v_max3_f32 v212, v74, v75, v212
    v_max3_f32 v212, v76, v77, v212
    v_max3_f32 v212, v78, v79, v212
    s_sub_u32 s52, s52, 1
    s_cmp_lg_u32 s52, 0
    s_cbranch_scc1 L_s1
    s_lshl_b32 s53, s28, 10
    v_lshlrev_b32 v8, 2, v2
    v_add_u32 v9, s53, v8
    ds_write_b32 v9, v209 offset:0
    ds_write_b32 v9, v210 offset:256
    ds_write_b32 v9, v211 offset:512
    ds_write_b32 v9, v212 offset:768
    s_lshl_b32 s53, s34, 10
    v_lshlrev_b32 v8, 2, v3
    v_add_u32 v9, s53, v8
    s_waitcnt lgkmcnt(0)
    s_barrier
    ds_read_b32 v16, v9 offset:0
    ds_read_b32 v17, v9 offset:128
    ds_read_b32 v18, v9 offset:2048
    ds_read_b32 v19, v9 offset:2176
    ds_read_b32 v20, v9 offset:4096
    ds_read_b32 v21, v9 offset:4224
    ds_read_b32 v22, v9 offset:6144
    ds_read_b32 v23, v9 offset:6272
    s_waitcnt lgkmcnt(0)
    v_max3_f32 v209, v16, v17, v18
    v_max3_f32 v209, v19, v20, v209
    v_max3_f32 v209, v21, v22, v209
    v_max_f32 v209, v23, v209
    ds_read_b32 v16, v9 offset:256
    ds_read_b32 v17, v9 offset:384
    ds_read_b32 v18, v9 offset:2304
    ds_read_b32 v19, v9 offset:2432
    ds_read_b32 v20, v9 offset:4352
    ds_read_b32 v21, v9 offset:4480
    ds_read_b32 v22, v9 offset:6400
    ds_read_b32 v23, v9 offset:6528
    s_waitcnt lgkmcnt(0)
    v_max3_f32 v210, v16, v17, v18
    v_max3_f32 v210, v19, v20, v210
    v_max3_f32 v210, v21, v22, v210
    v_max_f32 v210, v23, v210
    ds_read_b32 v16, v9 offset:512
    ds_read_b32 v17, v9 offset:640
    ds_read_b32 v18, v9 offset:2560
    ds_read_b32 v19, v9 offset:2688
    ds_read_b32 v20, v9 offset:4608
    ds_read_b32 v21, v9 offset:4736
    ds_read_b32 v22, v9 offset:6656
    ds_read_b32 v23, v9 offset:6784
    s_waitcnt lgkmcnt(0)
    v_max3_f32 v211, v16, v17, v18
    v_max3_f32 v211, v19, v20, v211
    v_max3_f32 v211, v21, v22, v211
    v_max_f32 v211, v23, v211
    ds_read_b32 v16, v9 offset:768
    ds_read_b32 v17, v9 offset:896
    ds_read_b32 v18, v9 offset:2816
    ds_read_b32 v19, v9 offset:2944
    ds_read_b32 v20, v9 offset:4864
    ds_read_b32 v21, v9 offset:4992
    ds_read_b32 v22, v9 offset:6912
    ds_read_b32 v23, v9 offset:7040
    s_waitcnt lgkmcnt(0)
    v_max3_f32 v212, v16, v17, v18
    v_max3_f32 v212, v19, v20, v212
    v_max3_f32 v212, v21, v22, v212
    v_max_f32 v212, v23, v212
    s_barrier
    s_mov_b32 s52, 16
L_s2:
    s_add_u32 s48, s42, s45
    s_add_u32 s49, s43, s45
    buffer_load_dwordx4 v[160:163], v4, s[24:27], s48 offen sc1
    s_mov_b64 exec, s[46:47]
    buffer_load_dwordx4 v[176:179], v5, s[24:27], s49 offen sc1
    buffer_load_dwordx4 v[180:183], v5, s[24:27], s49 offen offset:512 sc1
    s_mov_b64 exec, -1
    s_add_u32 s45, s45, 1024
    s_and_b32 s45, s45, 0x3fff
    s_waitcnt vmcnt(0)
    v_mfma_f32_32x32x16_bf16 v[16:31], v[160:163], v[144:147], 0
    v_mfma_f32_32x32x16_bf16 v[32:47], v[160:163], v[148:151], 0
    v_mfma_f32_32x32x16_bf16 v[48:63], v[160:163], v[152:155], 0
    v_mfma_f32_32x32x16_bf16 v[64:79], v[160:163], v[156:159], 0
    s_nop 15
    v_sub_f32 v16, v16, v209
    v_sub_f32 v17, v17, v209
    v_sub_f32 v18, v18, v209
    v_sub_f32 v19, v19, v209
    v_sub_f32 v20, v20, v209
    v_sub_f32 v21, v21, v209
    v_sub_f32 v22, v22, v209
    v_sub_f32 v23, v23, v209
    v_sub_f32 v24, v24, v209
    v_sub_f32 v25, v25, v209
    v_sub_f32 v26, v26, v209
    v_sub_f32 v27, v27, v209
    v_sub_f32 v28, v28, v209
    v_sub_f32 v29, v29, v209
    v_sub_f32 v30, v30, v209
    v_sub_f32 v31, v31, v209
    v_exp_f32 v16, v16
    v_exp_f32 v17, v17
    v_exp_f32 v18, v18
    v_exp_f32 v19, v19
    v_exp_f32 v20, v20
    v_exp_f32 v21, v21
    v_exp_f32 v22, v22
    v_exp_f32 v23, v23
    v_exp_f32 v24, v24
    v_exp_f32 v25, v25
    v_exp_f32 v26, v26
    v_exp_f32 v27, v27
    v_exp_f32 v28, v28
    v_exp_f32 v29, v29
    v_exp_f32 v30, v30
    v_exp_f32 v31, v31
    s_nop 1
    v_smfmac_f32_32x32x32_bf16 v[80:95], v[176:179], v[16:23], v208
    v_smfmac_f32_32x32x32_bf16 v[80:95], v[180:183], v[24:31], v208
    v_sub_f32 v32, v32, v210
    v_sub_f32 v33, v33, v210
    v_sub_f32 v34, v34, v210
    v_sub_f32 v35, v35, v210
    v_sub_f32 v36, v36, v210
    v_sub_f32 v37, v37, v210
    v_sub_f32 v38, v38, v210
    v_sub_f32 v39, v39, v210
    v_sub_f32 v40, v40, v210
    v_sub_f32 v41, v41, v210
    v_sub_f32 v42, v42, v210
    v_sub_f32 v43, v43, v210
    v_sub_f32 v44, v44, v210
    v_sub_f32 v45, v45, v210
    v_sub_f32 v46, v46, v210
    v_sub_f32 v47, v47, v210
    v_exp_f32 v32, v32
    v_exp_f32 v33, v33
    v_exp_f32 v34, v34
    v_exp_f32 v35, v35
    v_exp_f32 v36, v36
    v_exp_f32 v37, v37
    v_exp_f32 v38, v38
    v_exp_f32 v39, v39
    v_exp_f32 v40, v40
    v_exp_f32 v41, v41
    v_exp_f32 v42, v42
    v_exp_f32 v43, v43
    v_exp_f32 v44, v44
    v_exp_f32 v45, v45
    v_exp_f32 v46, v46
    v_exp_f32 v47, v47
    s_nop 1
    v_smfmac_f32_32x32x32_bf16 v[96:111], v[176:179], v[32:39], v208
    v_smfmac_f32_32x32x32_bf16 v[96:111], v[180:183], v[40:47], v208
    v_sub_f32 v48, v48, v211
    v_sub_f32 v49, v49, v211
    v_sub_f32 v50, v50, v211
    v_sub_f32 v51, v51, v211
    v_sub_f32 v52, v52, v211
    v_sub_f32 v53, v53, v211
    v_sub_f32 v54, v54, v211
    v_sub_f32 v55, v55, v211
    v_sub_f32 v56, v56, v211
    v_sub_f32 v57, v57, v211
    v_sub_f32 v58, v58, v211
    v_sub_f32 v59, v59, v211
    v_sub_f32 v60, v60, v211
    v_sub_f32 v61, v61, v211
    v_sub_f32 v62, v62, v211
    v_sub_f32 v63, v63, v211
    v_exp_f32 v48, v48
    v_exp_f32 v49, v49
    v_exp_f32 v50, v50
    v_exp_f32 v51, v51
    v_exp_f32 v52, v52
    v_exp_f32 v53, v53
    v_exp_f32 v54, v54
    v_exp_f32 v55, v55
    v_exp_f32 v56, v56
    v_exp_f32 v57, v57
    v_exp_f32 v58, v58
    v_exp_f32 v59, v59
    v_exp_f32 v60, v60
    v_exp_f32 v61, v61
    v_exp_f32 v62, v62
    v_exp_f32 v63, v63
    s_nop 1
    v_smfmac_f32_32x32x32_bf16 v[112:127], v[176:179], v[48:55], v208
    v_smfmac_f32_32x32x32_bf16 v[112:127], v[180:183], v[56:63], v208
    v_sub_f32 v64, v64, v212
    v_sub_f32 v65, v65, v212
    v_sub_f32 v66, v66, v212
    v_sub_f32 v67, v67, v212
    v_sub_f32 v68, v68, v212
    v_sub_f32 v69, v69, v212
    v_sub_f32 v70, v70, v212
    v_sub_f32 v71, v71, v212
    v_sub_f32 v72, v72, v212
    v_sub_f32 v73, v73, v212
    v_sub_f32 v74, v74, v212
    v_sub_f32 v75, v75, v212
    v_sub_f32 v76, v76, v212
    v_sub_f32 v77, v77, v212
    v_sub_f32 v78, v78, v212
    v_sub_f32 v79, v79, v212
    v_exp_f32 v64, v64
    v_exp_f32 v65, v65
    v_exp_f32 v66, v66
    v_exp_f32 v67, v67
    v_exp_f32 v68, v68
    v_exp_f32 v69, v69
    v_exp_f32 v70, v70
    v_exp_f32 v71, v71
    v_exp_f32 v72, v72
    v_exp_f32 v73, v73
    v_exp_f32 v74, v74
    v_exp_f32 v75, v75
    v_exp_f32 v76, v76
    v_exp_f32 v77, v77
    v_exp_f32 v78, v78
    v_exp_f32 v79, v79
    s_nop 1
    v_smfmac_f32_32x32x32_bf16 v[128:143], v[176:179], v[64:71], v208
    v_smfmac_f32_32x32x32_bf16 v[128:143], v[180:183], v[72:79], v208
    s_nop 7
    s_sub_u32 s52, s52, 1
    s_cmp_lg_u32 s52, 0
    s_cbranch_scc1 L_s2
    s_branch L_combine
code_end:
    s_endpgm
.section .rodata,"a"
.p2align 6
.amdhsa_kernel sequential_preLN__mha_block__moe_arch_mod__prompt_kernel
  .amdhsa_next_free_vgpr 256
  .amdhsa_next_free_sgpr 100
  .amdhsa_accum_offset 256
  .amdhsa_group_segment_fixed_size 0
  .amdhsa_kernarg_size 88
  .amdhsa_user_sgpr_count 2
  .amdhsa_user_sgpr_kernarg_segment_ptr 1
  .amdhsa_system_sgpr_workgroup_id_x 1
.end_amdhsa_kernel
```
